```python
import torch

def _softmax(x, axis=-1):
    return torch.softmax(x, dim=axis)
def _gelu(x):
    return torch.nn.functional.gelu(x, approximate="tanh")
def _silu(x):
    return torch.nn.functional.silu(x)
def _sigmoid(x):
    return torch.sigmoid(x)
def _layernorm(x, axis=-1, eps=1e-5):
    m = x.mean(dim=axis, keepdim=True)
    v = x.var(dim=axis, keepdim=True, unbiased=False)
    return (x - m) / torch.sqrt(v + eps)
def _scatter_add(tgt, idx, src, axis=0):
    return tgt.clone().index_add_(axis, idx, src)
def _segment_sum(src, seg, n):
    out = torch.zeros((n,) + src.shape[1:], dtype=src.dtype)
    return out.index_add_(0, seg, src)
def _pad(x, pw):
    flat = tuple(v for pair in reversed(pw) for v in pair)
    return torch.nn.functional.pad(x, flat)

kernel_name = 'sequential_preLN__mha_block__glu_gated_swiglu__prompt'

def setup_inputs():

    _w = (lambda a: (lambda t: t.to(torch.bfloat16) if t.is_floating_point() else t)(torch.as_tensor(a)))
    def _A_setup():
        B, S, D, H = 1, 2048, 448, 16
        return {
            "x": _w((lambda *s: torch.randn(*s, dtype=torch.bfloat16) * 0.05)(B, S, D)),
            "wqkv": _w((lambda *s: torch.randn(*s, dtype=torch.bfloat16) * 0.05)(D, 3 * D)),
            "wo": _w((lambda *s: torch.randn(*s, dtype=torch.bfloat16) * 0.05)(D, D)),
        }
    _A_in = _A_setup()

    def _B_setup():
        B, S, D, F = 1, 2048, 448, 1792
        return {
            "x": _w((lambda *s: torch.randn(*s, dtype=torch.bfloat16) * 0.05)(B, S, D)),
            "w1": _w((lambda *s: torch.randn(*s, dtype=torch.bfloat16) * 0.4)(D, F) * (2.0 / D) ** 0.5),
            "w3": _w((lambda *s: torch.randn(*s, dtype=torch.bfloat16) * 0.4)(D, F) * (2.0 / D) ** 0.5),
            "w2": _w((lambda *s: torch.randn(*s, dtype=torch.bfloat16) * 0.4)(F, D) * (2.0 / F) ** 0.5),
        }
    _B_in = _B_setup()

    return {
        "A_x": _A_in["x"],
        "A_wqkv": _A_in["wqkv"],
        "A_wo": _A_in["wo"],
        "B_x": _B_in["x"],
        "B_w1": _B_in["w1"],
        "B_w3": _B_in["w3"],
        "B_w2": _B_in["w2"],
    }

def reference(A_x, A_wqkv, A_wo, B_x, B_w1, B_w3, B_w2):
    def _A_ref(x, wqkv, wo):
        B, S, D = x.shape
        H = 16
        Dh = D // H
        qkv = (lambda x, *d: x.permute(*d))((x @ wqkv).reshape(B, S, 3, H, Dh), 2, 0, 3, 1, 4)
        q, k, v = qkv[0], qkv[1], qkv[2]
        scores = torch.einsum("bhqd,bhkd->bhqk", q, k) * (Dh ** -0.5)
        p = _softmax(scores, axis=-1)
        o = torch.einsum("bhqk,bhkd->bhqd", p, v)
        return (lambda x, *d: x.permute(*d))(o, 0, 2, 1, 3).reshape(B, S, D) @ wo

    def _B_ref(x, w1, w3, w2):
        gate = torch.einsum("bsd,df->bsf", x, w1)
        up = torch.einsum("bsd,df->bsf", x, w3)
        h = _silu(gate) * up
        out = torch.einsum("bsf,fd->bsd", h, w2)
        return out

    x = A_x
    h = x + _A_ref(_layernorm(x, axis=-1), A_wqkv, A_wo)
    h2 = h + _B_ref(_layernorm(h, axis=-1), B_w1, B_w3, B_w2)
    return h2
```

```asm
; @launch grid=(256,1,1) block=(768,1,1) lds=163840
.amdgcn_target "amdgcn-amd-amdhsa--gfx950"
.text
.globl sequential_preLN__mha_block__glu_gated_swiglu__prompt_kernel
.p2align 8
.type sequential_preLN__mha_block__glu_gated_swiglu__prompt_kernel,@function
sequential_preLN__mha_block__glu_gated_swiglu__prompt_kernel:
    s_cmp_ge_u32 s2, 256
    s_cbranch_scc1 exit_now
    s_load_dwordx16 s[36:51], s[0:1], 0
    s_load_dwordx4 s[52:55], s[0:1], 64
    v_lshrrev_b32 v1, 6, v0
    v_and_b32 v0, 63, v0
    v_readfirstlane_b32 s3, v1
    s_and_b32 s4, s2, 7
    s_lshr_b32 s5, s2, 3
    v_lshlrev_b32 v1, 4, v0
    s_and_b32 s58, s3, 3
    s_cmp_lt_u32 s3, 8
    s_cbranch_scc1 compute
    s_setprio 3
    v_mov_b32 v2, 0
    v_mov_b32 v3, 1
    s_and_b32 s6, s4, 1
    s_lshl_b32 s6, s6, 3
    s_and_b32 s7, s5, 7
    s_add_u32 s32, s6, s7
    s_lshr_b32 s6, s4, 1
    s_lshl_b32 s6, s6, 2
    s_lshr_b32 s56, s5, 3
    s_add_u32 s33, s6, s56
    s_add_u32 s34, s7, s56
    s_and_b32 s34, s34, 3
    s_lshl_b32 s34, s34, 1
    s_mov_b32 s67, s34
    v_lshrrev_b32 v4, 3, v0
    s_lshl_b32 s6, s58, 5
    v_add_u32 v4, s6, v4
    v_mul_u32_u24 v4, 896, v4
    v_lshrrev_b32 v5, 4, v0
    v_and_b32 v6, 7, v0
    v_xor_b32 v5, v5, v6
    v_lshl_add_u32 v11, v5, 4, v4
    v_xor_b32 v5, 4, v5
    v_lshl_add_u32 v12, v5, 4, v4
    v_add_u32 v12, 7168, v12
    v_add_u32 v13, 14336, v11
    v_add_u32 v14, 14336, v12
    s_lshl_b32 s35, s58, 11
    s_lshl_b32 s64, s58, 12
    s_mul_i32 s6, s33, 114688
    s_waitcnt lgkmcnt(0)
    s_mov_b32 s8, s36
    s_mov_b32 s9, s37
    s_mov_b32 s10, 0x1c000
    s_mov_b32 s11, 0x20000
    s_add_u32 s8, s8, s6
    s_addc_u32 s9, s9, 0
    s_mov_b32 s12, s38
    s_mov_b32 s13, s39
    s_mov_b32 s14, 0x126000
    s_mov_b32 s15, 0x20000
    s_lshl_b32 s66, s34, 7
    s_add_u32 m0, s64, 0
    s_nop 0
    buffer_load_dwordx4 v11, s[8:11], s66 offen lds
    s_add_u32 m0, s64, 1024
    s_nop 0
    buffer_load_dwordx4 v12, s[8:11], s66 offen lds
    s_add_u32 m0, s64, 2048
    s_nop 0
    buffer_load_dwordx4 v13, s[8:11], s66 offen lds
    s_add_u32 m0, s64, 3072
    s_nop 0
    buffer_load_dwordx4 v14, s[8:11], s66 offen lds
    v_lshrrev_b32 v4, 3, v0
    s_lshl_b32 s6, s58, 4
    v_add_u32 v4, s6, v4
    v_mul_u32_u24 v8, 2688, v4
    v_bfe_u32 v4, v0, 4, 1
    v_lshlrev_b32 v4, 2, v4
    v_and_b32 v5, 7, v0
    v_xor_b32 v4, v4, v5
    v_lshl_add_u32 v8, v4, 4, v8
    s_mul_i32 s6, s32, 112
    s_add_u32 s6, s6, 896
    v_add_u32 v8, s6, v8
    v_add_u32 v9, 21504, v8
    s_mul_i32 s65, s34, 172032
    s_mov_b32 exec_lo, 0xf7f77f7f
    s_mov_b32 exec_hi, 0xf7f77f7f
    s_add_u32 m0, s35, 114688
    s_nop 0
    buffer_load_dwordx4 v8, s[12:15], s65 offen lds
    s_add_u32 m0, s35, 115712
    s_nop 0
    buffer_load_dwordx4 v9, s[12:15], s65 offen lds
    s_mov_b64 exec, -1
    s_add_u32 s34, s34, 1
    s_cmp_eq_u32 s34, 7
    s_cselect_b32 s34, 0, s34
    v_lshrrev_b32 v4, 2, v0
    s_lshl_b32 s6, s58, 4
    v_add_u32 v4, s6, v4
    v_mul_u32_u24 v10, 2688, v4
    v_and_b32 v4, 3, v0
    v_lshl_add_u32 v10, v4, 4, v10
    s_mul_i32 s6, s32, 56
    s_and_b32 s6, s6, 0xfffffff0
    v_add_u32 v10, s6, v10
    s_mul_i32 s6, s5, 9
    s_sub_i32 s7, (code_end-cpf_base)>>7, s6
    s_max_i32 s7, s7, 0
    s_min_i32 s7, s7, 9
    s_cmp_eq_u32 s3, 10
    s_cselect_b32 s18, s7, 0
    s_getpc_b64 s[16:17]
cpf_base:
    s_lshl_b32 s6, s6, 7
    s_and_b32 s16, s16, 0xffffff80
    s_add_u32 s16, s16, s6
    s_addc_u32 s17, s17, 0x800000
    s_mov_b32 s19, 0x20000
    buffer_load_dword v7, v0, s[16:19], 0 idxen
    s_add_u32 s60, s54, 0xa90000
    s_addc_u32 s61, s55, 0
    s_mov_b32 s62, 0x8000
    s_mov_b32 s63, 0x20000
    s_add_u32 s89, s54, 0xa90000
    s_lshr_b32 s89, s89, 19
    s_xor_b32 s89, s89, s4
    s_and_b32 s89, s89, 4
    s_lshl_b32 s89, s89, 11
    s_mov_b32 s16, s52
    s_mov_b32 s17, s53
    s_mov_b32 s18, 0x100
    s_mov_b32 s19, 0x20000
    s_lshl_b32 s66, s34, 7
    s_add_u32 m0, s64, 16384
    s_nop 0
    buffer_load_dwordx4 v11, s[8:11], s66 offen lds
    s_add_u32 m0, s64, 17408
    s_nop 0
    buffer_load_dwordx4 v12, s[8:11], s66 offen lds
    s_add_u32 m0, s64, 18432
    s_nop 0
    buffer_load_dwordx4 v13, s[8:11], s66 offen lds
    s_add_u32 m0, s64, 19456
    s_nop 0
    buffer_load_dwordx4 v14, s[8:11], s66 offen lds
    s_mul_i32 s65, s34, 172032
    s_mov_b32 exec_lo, 0xf7f77f7f
    s_mov_b32 exec_hi, 0xf7f77f7f
    s_add_u32 m0, s35, 122880
    s_nop 0
    buffer_load_dwordx4 v8, s[12:15], s65 offen lds
    s_add_u32 m0, s35, 123904
    s_nop 0
    buffer_load_dwordx4 v9, s[12:15], s65 offen lds
    s_mov_b64 exec, -1
    s_add_u32 s34, s34, 1
    s_cmp_eq_u32 s34, 7
    s_cselect_b32 s34, 0, s34
    s_waitcnt vmcnt(7)
    s_barrier
    s_lshl_b32 s66, s34, 7
    s_add_u32 m0, s64, 32768
    s_nop 0
    buffer_load_dwordx4 v11, s[8:11], s66 offen lds
    s_add_u32 m0, s64, 33792
    s_nop 0
    buffer_load_dwordx4 v12, s[8:11], s66 offen lds
    s_add_u32 m0, s64, 34816
    s_nop 0
    buffer_load_dwordx4 v13, s[8:11], s66 offen lds
    s_add_u32 m0, s64, 35840
    s_nop 0
    buffer_load_dwordx4 v14, s[8:11], s66 offen lds
    s_mul_i32 s65, s34, 172032
    s_mov_b32 exec_lo, 0xf7f77f7f
    s_mov_b32 exec_hi, 0xf7f77f7f
    s_add_u32 m0, s35, 131072
    s_nop 0
    buffer_load_dwordx4 v8, s[12:15], s65 offen lds
    s_add_u32 m0, s35, 132096
    s_nop 0
    buffer_load_dwordx4 v9, s[12:15], s65 offen lds
    s_mov_b64 exec, -1
    s_add_u32 s34, s34, 1
    s_cmp_eq_u32 s34, 7
    s_cselect_b32 s34, 0, s34
    s_waitcnt vmcnt(6)
    s_barrier
    s_lshl_b32 s66, s34, 7
    s_add_u32 m0, s64, 49152
    s_nop 0
    buffer_load_dwordx4 v11, s[8:11], s66 offen lds
    s_add_u32 m0, s64, 50176
    s_nop 0
    buffer_load_dwordx4 v12, s[8:11], s66 offen lds
    s_add_u32 m0, s64, 51200
    s_nop 0
    buffer_load_dwordx4 v13, s[8:11], s66 offen lds
    s_add_u32 m0, s64, 52224
    s_nop 0
    buffer_load_dwordx4 v14, s[8:11], s66 offen lds
    s_mul_i32 s65, s34, 172032
    s_mov_b32 exec_lo, 0xf7f77f7f
    s_mov_b32 exec_hi, 0xf7f77f7f
    s_add_u32 m0, s35, 114688
    s_nop 0
    buffer_load_dwordx4 v8, s[12:15], s65 offen lds
    s_add_u32 m0, s35, 115712
    s_nop 0
    buffer_load_dwordx4 v9, s[12:15], s65 offen lds
    s_mov_b64 exec, -1
    s_add_u32 s34, s34, 1
    s_cmp_eq_u32 s34, 7
    s_cselect_b32 s34, 0, s34
    s_waitcnt vmcnt(6)
    s_barrier
    s_lshl_b32 s66, s34, 7
    s_add_u32 m0, s64, 65536
    s_nop 0
    buffer_load_dwordx4 v11, s[8:11], s66 offen lds
    s_add_u32 m0, s64, 66560
    s_nop 0
    buffer_load_dwordx4 v12, s[8:11], s66 offen lds
    s_add_u32 m0, s64, 67584
    s_nop 0
    buffer_load_dwordx4 v13, s[8:11], s66 offen lds
    s_add_u32 m0, s64, 68608
    s_nop 0
    buffer_load_dwordx4 v14, s[8:11], s66 offen lds
    s_mul_i32 s65, s34, 172032
    s_mov_b32 exec_lo, 0xf7f77f7f
    s_mov_b32 exec_hi, 0xf7f77f7f
    s_add_u32 m0, s35, 122880
    s_nop 0
    buffer_load_dwordx4 v8, s[12:15], s65 offen lds
    s_add_u32 m0, s35, 123904
    s_nop 0
    buffer_load_dwordx4 v9, s[12:15], s65 offen lds
    s_mov_b64 exec, -1
    s_add_u32 s34, s34, 1
    s_cmp_eq_u32 s34, 7
    s_cselect_b32 s34, 0, s34
    s_waitcnt vmcnt(6)
    s_barrier
    s_lshl_b32 s66, s34, 7
    s_add_u32 m0, s64, 81920
    s_nop 0
    buffer_load_dwordx4 v11, s[8:11], s66 offen lds
    s_add_u32 m0, s64, 82944
    s_nop 0
    buffer_load_dwordx4 v12, s[8:11], s66 offen lds
    s_add_u32 m0, s64, 83968
    s_nop 0
    buffer_load_dwordx4 v13, s[8:11], s66 offen lds
    s_add_u32 m0, s64, 84992
    s_nop 0
    buffer_load_dwordx4 v14, s[8:11], s66 offen lds
    s_mul_i32 s65, s34, 172032
    s_mov_b32 exec_lo, 0xf7f77f7f
    s_mov_b32 exec_hi, 0xf7f77f7f
    s_add_u32 m0, s35, 131072
    s_nop 0
    buffer_load_dwordx4 v8, s[12:15], s65 offen lds
    s_add_u32 m0, s35, 132096
    s_nop 0
    buffer_load_dwordx4 v9, s[12:15], s65 offen lds
    s_mov_b64 exec, -1
    s_add_u32 s34, s34, 1
    s_cmp_eq_u32 s34, 7
    s_cselect_b32 s34, 0, s34
    s_waitcnt vmcnt(6)
    s_barrier
    s_lshl_b32 s66, s34, 7
    s_add_u32 m0, s64, 98304
    s_nop 0
    buffer_load_dwordx4 v11, s[8:11], s66 offen lds
    s_add_u32 m0, s64, 99328
    s_nop 0
    buffer_load_dwordx4 v12, s[8:11], s66 offen lds
    s_add_u32 m0, s64, 100352
    s_nop 0
    buffer_load_dwordx4 v13, s[8:11], s66 offen lds
    s_add_u32 m0, s64, 101376
    s_nop 0
    buffer_load_dwordx4 v14, s[8:11], s66 offen lds
    s_mul_i32 s65, s34, 172032
    s_mov_b32 exec_lo, 0xf7f77f7f
    s_mov_b32 exec_hi, 0xf7f77f7f
    s_add_u32 m0, s35, 114688
    s_nop 0
    buffer_load_dwordx4 v8, s[12:15], s65 offen lds
    s_add_u32 m0, s35, 115712
    s_nop 0
    buffer_load_dwordx4 v9, s[12:15], s65 offen lds
    s_mov_b64 exec, -1
    s_add_u32 s34, s34, 1
    s_cmp_eq_u32 s34, 7
    s_cselect_b32 s34, 0, s34
    buffer_load_dword v24, v2, s[16:19], 0 offen sc1
    s_mul_i32 s65, s67, 172032
    s_lshr_b32 s6, s35, 1
    s_add_u32 m0, s6, 139264
    s_add_u32 s67, s67, 1
    s_cmp_eq_u32 s67, 7
    s_cselect_b32 s67, 0, s67
    buffer_load_dwordx4 v10, s[12:15], s65 offen lds
    s_mul_i32 s65, s67, 172032
    s_lshr_b32 s6, s35, 1
    s_add_u32 m0, s6, 143360
    s_add_u32 s67, s67, 1
    s_cmp_eq_u32 s67, 7
    s_cselect_b32 s67, 0, s67
    buffer_load_dwordx4 v10, s[12:15], s65 offen lds
    s_mul_i32 s65, s67, 172032
    s_lshr_b32 s6, s35, 1
    s_add_u32 m0, s6, 147456
    s_add_u32 s67, s67, 1
    s_cmp_eq_u32 s67, 7
    s_cselect_b32 s67, 0, s67
    buffer_load_dwordx4 v10, s[12:15], s65 offen lds
    s_mul_i32 s65, s67, 172032
    s_lshr_b32 s6, s35, 1
    s_add_u32 m0, s6, 151552
    s_add_u32 s67, s67, 1
    s_cmp_eq_u32 s67, 7
    s_cselect_b32 s67, 0, s67
    buffer_load_dwordx4 v10, s[12:15], s65 offen lds
    s_mul_i32 s65, s67, 172032
    s_lshr_b32 s6, s35, 1
    s_add_u32 m0, s6, 155648
    s_add_u32 s67, s67, 1
    s_cmp_eq_u32 s67, 7
    s_cselect_b32 s67, 0, s67
    buffer_load_dwordx4 v10, s[12:15], s65 offen lds
    s_waitcnt vmcnt(12)
    s_barrier
    s_mul_i32 s65, s67, 172032
    s_lshr_b32 s6, s35, 1
    s_add_u32 m0, s6, 122880
    s_add_u32 s67, s67, 1
    s_cmp_eq_u32 s67, 7
    s_cselect_b32 s67, 0, s67
    buffer_load_dwordx4 v10, s[12:15], s65 offen lds
    s_mul_i32 s65, s67, 172032
    s_lshr_b32 s6, s35, 1
    s_add_u32 m0, s6, 126976
    s_add_u32 s67, s67, 1
    s_cmp_eq_u32 s67, 7
    s_cselect_b32 s67, 0, s67
    buffer_load_dwordx4 v10, s[12:15], s65 offen lds
    s_waitcnt vmcnt(8)
    s_barrier
    s_cmp_lg_u32 s3, 11
    s_cbranch_scc1 ld_ready
    s_waitcnt vmcnt(7)
    v_cmp_le_u32 vcc, 18, v24
    s_nop 0
    s_cbranch_vccnz ld_ready
    v_mov_b32 v5, 18
    s_mov_b64 exec, 1
    s_mov_b32 s59, 0
poll_1:
    s_sleep 2
    buffer_load_dword v4, v2, s[16:19], 0 offen sc1
    s_add_u32 s59, s59, 1
    s_cmp_gt_u32 s59, 0x100000
    s_cbranch_scc1 polle_2
    s_waitcnt vmcnt(0)
    v_cmp_lt_u32 vcc, v4, v5
    s_nop 0
    s_cbranch_vccnz poll_1
polle_2:
    s_mov_b64 exec, -1
ld_ready:
    s_lshl_b32 s65, s32, 7
    s_and_b32 s6, s4, 1
    s_lshl_b32 s6, s6, 3
    s_and_b32 s7, s5, 7
    s_add_u32 s32, s6, s7
    s_lshr_b32 s6, s4, 1
    s_lshl_b32 s6, s6, 2
    s_lshr_b32 s56, s5, 3
    s_add_u32 s33, s6, s56
    s_lshl_b32 s6, s32, 17
    s_add_u32 s8, s54, 0x200000
    s_addc_u32 s9, s55, 0
    s_mov_b32 s10, 0x20000
    s_mov_b32 s11, 0x20000
    s_add_u32 s8, s8, s6
    s_addc_u32 s9, s9, 0
    s_add_u32 s12, s54, 0x400000
    s_addc_u32 s13, s55, 0
    s_mov_b32 s14, 0x20000
    s_mov_b32 s15, 0x20000
    s_add_u32 s12, s12, s6
    s_addc_u32 s13, s13, 0
    s_lshl_b32 s34, s58, 11
    s_lshl_b32 s35, s58, 12
    s_lshl_b32 s6, s4, 2
    s_and_b32 s76, s5, 3
    s_add_u32 s76, s76, s6
    s_lshr_b32 s77, s5, 2
    s_lshl_b32 s57, s77, 7
    v_lshrrev_b32 v4, 3, v0
    v_mul_u32_u24 v8, 896, v4
    v_bfe_u32 v4, v0, 4, 1
    v_lshlrev_b32 v4, 2, v4
    v_and_b32 v5, 7, v0
    v_xor_b32 v4, v4, v5
    v_lshl_add_u32 v8, v4, 4, v8
    v_add_u32 v8, s57, v8
    s_mov_b32 s20, s40
    s_mov_b32 s21, s41
    s_mov_b32 s22, 0x62000
    s_mov_b32 s23, 0x20000
    s_cmp_lt_u32 s5, 28
    s_cselect_b32 s22, s22, 0
    s_mul_i32 s64, s58, 14336
    s_lshl_b32 s66, s58, 11
    s_add_u32 s66, s66, 98304
    v_lshlrev_b32 v9, 3, v0
    s_lshr_b32 s6, s32, 1
    v_add_u32 v9, s6, v9
    v_lshlrev_b32 v9, 7, v9
    v_add_u32 v9, s89, v9
    v_lshlrev_b32 v15, 13, v0
    v_mov_b32 v10, 16
    s_waitcnt vmcnt(0)
    s_barrier
    s_barrier
    s_cmp_lg_u32 s3, 8
    s_cbranch_scc1 sig_3
    s_mov_b64 exec, 3
    buffer_atomic_add v3, v15, s[60:63], s65 offen sc1
    s_mov_b64 exec, -1
sig_3:
    s_cmp_lg_u32 s3, 11
    s_cbranch_scc1 ld_w1
    s_mov_b64 exec, 3
    s_mov_b32 s59, 0
    s_sleep 20
poll_4:
    s_sleep 2
    buffer_load_dword v4, v9, s[60:63], 0 offen sc1
    s_add_u32 s59, s59, 1
    s_cmp_gt_u32 s59, 0x100000
    s_cbranch_scc1 polle_5
    s_waitcnt vmcnt(0)
    v_cmp_lt_u32 vcc, v4, v10
    s_nop 0
    s_cbranch_vccnz poll_4
polle_5:
    s_mov_b64 exec, -1
ld_w1:
    s_barrier
    s_mul_i32 s82, s2, 12
    s_add_u32 s82, s82, s3
    s_add_u32 s6, s34, 0
    s_add_u32 m0, s35, 0
    s_nop 0
    buffer_load_dwordx4 v1, s[8:11], s6 offen sc1 lds
    buffer_load_dwordx4 v1, s[8:11], s6 offen offset:1024 sc1 lds
    s_add_u32 s6, s34, 65536
    s_add_u32 m0, s35, 16384
    s_nop 0
    buffer_load_dwordx4 v1, s[8:11], s6 offen sc1 lds
    buffer_load_dwordx4 v1, s[8:11], s6 offen offset:1024 sc1 lds
    s_add_u32 s6, s34, 0
    s_add_u32 m0, s35, 2048
    s_nop 0
    buffer_load_dwordx4 v1, s[12:15], s6 offen sc1 lds
    buffer_load_dwordx4 v1, s[12:15], s6 offen offset:1024 sc1 lds
    s_add_u32 s6, s34, 65536
    s_add_u32 m0, s35, 18432
    s_nop 0
    buffer_load_dwordx4 v1, s[12:15], s6 offen sc1 lds
    buffer_load_dwordx4 v1, s[12:15], s6 offen offset:1024 sc1 lds
    s_waitcnt vmcnt(4)
    s_barrier
    s_add_u32 s6, s34, 8192
    s_add_u32 m0, s35, 32768
    s_nop 0
    buffer_load_dwordx4 v1, s[8:11], s6 offen sc1 lds
    buffer_load_dwordx4 v1, s[8:11], s6 offen offset:1024 sc1 lds
    s_add_u32 m0, s35, 34816
    s_nop 0
    buffer_load_dwordx4 v1, s[12:15], s6 offen sc1 lds
    buffer_load_dwordx4 v1, s[12:15], s6 offen offset:1024 sc1 lds
    s_add_u32 s6, s34, 73728
    s_add_u32 m0, s35, 49152
    s_nop 0
    buffer_load_dwordx4 v1, s[8:11], s6 offen sc1 lds
    buffer_load_dwordx4 v1, s[8:11], s6 offen offset:1024 sc1 lds
    s_add_u32 m0, s35, 51200
    s_nop 0
    buffer_load_dwordx4 v1, s[12:15], s6 offen sc1 lds
    buffer_load_dwordx4 v1, s[12:15], s6 offen offset:1024 sc1 lds
    s_waitcnt vmcnt(8)
    s_barrier
    s_min_u32 m0, s66, 156672
    s_add_u32 s66, s66, 1024
    buffer_load_dwordx4 v8, s[20:23], s64 offen lds
    s_add_u32 s64, s64, 7168
    s_min_u32 m0, s66, 156672
    s_add_u32 s66, s66, 7168
    buffer_load_dwordx4 v8, s[20:23], s64 offen lds
    s_add_u32 s64, s64, 50176
    s_waitcnt vmcnt(2)
    s_barrier
    s_cmp_lg_u32 s82, 2710
    s_cbranch_scc1 ldpr_6
    s_mov_b32 s83, 0
    s_mov_b32 s84, 0
    s_mov_b32 s6, 16896
    s_mov_b32 s7, 25088
    v_mov_b32 v4, 0
    v_mov_b32 v5, 0
    s_mov_b64 exec, 1
    s_waitcnt vmcnt(0)
    buffer_atomic_add v4, v2, s[60:63], s6 offen sc0 sc1
    buffer_atomic_add v5, v2, s[60:63], s7 offen sc0 sc1
    s_waitcnt vmcnt(1)
    s_memtime s[86:87]
    s_waitcnt vmcnt(0)
    s_memtime s[68:69]
    s_waitcnt lgkmcnt(0)
    s_sub_u32 s85, s68, s86
    s_min_u32 s85, s85, 300
    s_add_u32 s83, s83, s85
    s_mov_b64 exec, -1
ldpr_6:
    s_add_u32 s6, s34, 16384
    s_add_u32 m0, s35, 65536
    s_nop 0
    buffer_load_dwordx4 v1, s[8:11], s6 offen sc1 lds
    buffer_load_dwordx4 v1, s[8:11], s6 offen offset:1024 sc1 lds
    s_add_u32 m0, s35, 67584
    s_nop 0
    buffer_load_dwordx4 v1, s[12:15], s6 offen sc1 lds
    buffer_load_dwordx4 v1, s[12:15], s6 offen offset:1024 sc1 lds
    s_add_u32 s6, s34, 81920
    s_add_u32 m0, s35, 81920
    s_nop 0
    buffer_load_dwordx4 v1, s[8:11], s6 offen sc1 lds
    buffer_load_dwordx4 v1, s[8:11], s6 offen offset:1024 sc1 lds
    s_add_u32 m0, s35, 83968
    s_nop 0
    buffer_load_dwordx4 v1, s[12:15], s6 offen sc1 lds
    buffer_load_dwordx4 v1, s[12:15], s6 offen offset:1024 sc1 lds
    s_min_u32 m0, s66, 156672
    s_add_u32 s66, s66, 1024
    buffer_load_dwordx4 v8, s[20:23], s64 offen lds
    s_add_u32 s64, s64, 7168
    s_min_u32 m0, s66, 156672
    s_add_u32 s66, s66, 7168
    buffer_load_dwordx4 v8, s[20:23], s64 offen lds
    s_add_u32 s64, s64, 50176
    s_waitcnt vmcnt(2)
    s_barrier
    s_cmp_lg_u32 s82, 2710
    s_cbranch_scc1 ldpr_7
    s_mov_b32 s6, 25088
    s_mov_b32 s7, 16896
    v_mov_b32 v4, 0
    v_mov_b32 v5, 0
    s_mov_b64 exec, 1
    s_waitcnt vmcnt(0)
    buffer_atomic_add v4, v2, s[60:63], s6 offen sc0 sc1
    buffer_atomic_add v5, v2, s[60:63], s7 offen sc0 sc1
    s_waitcnt vmcnt(1)
    s_memtime s[86:87]
    s_waitcnt vmcnt(0)
    s_memtime s[68:69]
    s_waitcnt lgkmcnt(0)
    s_sub_u32 s85, s68, s86
    s_min_u32 s85, s85, 300
    s_add_u32 s84, s84, s85
    s_mov_b64 exec, -1
ldpr_7:
    s_add_u32 s6, s34, 24576
    s_add_u32 m0, s35, 0
    s_nop 0
    buffer_load_dwordx4 v1, s[8:11], s6 offen sc1 lds
    buffer_load_dwordx4 v1, s[8:11], s6 offen offset:1024 sc1 lds
    s_add_u32 m0, s35, 2048
    s_nop 0
    buffer_load_dwordx4 v1, s[12:15], s6 offen sc1 lds
    buffer_load_dwordx4 v1, s[12:15], s6 offen offset:1024 sc1 lds
    s_add_u32 s6, s34, 90112
    s_add_u32 m0, s35, 16384
    s_nop 0
    buffer_load_dwordx4 v1, s[8:11], s6 offen sc1 lds
    buffer_load_dwordx4 v1, s[8:11], s6 offen offset:1024 sc1 lds
    s_add_u32 m0, s35, 18432
    s_nop 0
    buffer_load_dwordx4 v1, s[12:15], s6 offen sc1 lds
    buffer_load_dwordx4 v1, s[12:15], s6 offen offset:1024 sc1 lds
    s_min_u32 m0, s66, 156672
    s_add_u32 s66, s66, 1024
    buffer_load_dwordx4 v8, s[20:23], s64 offen lds
    s_add_u32 s64, s64, 7168
    s_min_u32 m0, s66, 156672
    s_add_u32 s66, s66, 7168
    buffer_load_dwordx4 v8, s[20:23], s64 offen lds
    s_add_u32 s64, s64, 50176
    s_waitcnt vmcnt(2)
    s_barrier
    s_cmp_lg_u32 s82, 2710
    s_cbranch_scc1 ldpr_8
    s_mov_b32 s6, 16896
    s_mov_b32 s7, 25088
    v_mov_b32 v4, 0
    v_mov_b32 v5, 0
    s_mov_b64 exec, 1
    s_waitcnt vmcnt(0)
    buffer_atomic_add v4, v2, s[60:63], s6 offen sc0 sc1
    buffer_atomic_add v5, v2, s[60:63], s7 offen sc0 sc1
    s_waitcnt vmcnt(1)
    s_memtime s[86:87]
    s_waitcnt vmcnt(0)
    s_memtime s[68:69]
    s_waitcnt lgkmcnt(0)
    s_sub_u32 s85, s68, s86
    s_min_u32 s85, s85, 300
    s_add_u32 s83, s83, s85
    s_mov_b64 exec, -1
ldpr_8:
    s_add_u32 s6, s34, 32768
    s_add_u32 m0, s35, 32768
    s_nop 0
    buffer_load_dwordx4 v1, s[8:11], s6 offen sc1 lds
    buffer_load_dwordx4 v1, s[8:11], s6 offen offset:1024 sc1 lds
    s_add_u32 m0, s35, 34816
    s_nop 0
    buffer_load_dwordx4 v1, s[12:15], s6 offen sc1 lds
    buffer_load_dwordx4 v1, s[12:15], s6 offen offset:1024 sc1 lds
    s_add_u32 s6, s34, 98304
    s_add_u32 m0, s35, 49152
    s_nop 0
    buffer_load_dwordx4 v1, s[8:11], s6 offen sc1 lds
    buffer_load_dwordx4 v1, s[8:11], s6 offen offset:1024 sc1 lds
    s_add_u32 m0, s35, 51200
    s_nop 0
    buffer_load_dwordx4 v1, s[12:15], s6 offen sc1 lds
    buffer_load_dwordx4 v1, s[12:15], s6 offen offset:1024 sc1 lds
    s_min_u32 m0, s66, 156672
    s_add_u32 s66, s66, 1024
    buffer_load_dwordx4 v8, s[20:23], s64 offen lds
    s_add_u32 s64, s64, 7168
    s_min_u32 m0, s66, 156672
    s_add_u32 s66, s66, 7168
    buffer_load_dwordx4 v8, s[20:23], s64 offen lds
    s_add_u32 s64, s64, 50176
    s_waitcnt vmcnt(2)
    s_barrier
    s_cmp_lg_u32 s82, 2710
    s_cbranch_scc1 ldpr_9
    s_mov_b32 s6, 25088
    s_mov_b32 s7, 16896
    v_mov_b32 v4, 0
    v_mov_b32 v5, 0
    s_mov_b64 exec, 1
    s_waitcnt vmcnt(0)
    buffer_atomic_add v4, v2, s[60:63], s6 offen sc0 sc1
    buffer_atomic_add v5, v2, s[60:63], s7 offen sc0 sc1
    s_waitcnt vmcnt(1)
    s_memtime s[86:87]
    s_waitcnt vmcnt(0)
    s_memtime s[68:69]
    s_waitcnt lgkmcnt(0)
    s_sub_u32 s85, s68, s86
    s_min_u32 s85, s85, 300
    s_add_u32 s84, s84, s85
    s_cmp_gt_u32 s84, s83
    s_cselect_b32 s6, 8192, 0
    s_cmp_eq_u32 s6, s89
    s_cselect_b32 s6, 1, 5
    v_mov_b32 v4, s6
    buffer_store_dword v4, v2, s[16:19], 0 offen offset:128 sc1
    s_waitcnt vmcnt(0)
    s_mov_b64 exec, -1
ldpr_9:
    s_add_u32 s6, s34, 40960
    s_add_u32 m0, s35, 65536
    s_nop 0
    buffer_load_dwordx4 v1, s[8:11], s6 offen sc1 lds
    buffer_load_dwordx4 v1, s[8:11], s6 offen offset:1024 sc1 lds
    s_add_u32 m0, s35, 67584
    s_nop 0
    buffer_load_dwordx4 v1, s[12:15], s6 offen sc1 lds
    buffer_load_dwordx4 v1, s[12:15], s6 offen offset:1024 sc1 lds
    s_add_u32 s6, s34, 106496
    s_add_u32 m0, s35, 81920
    s_nop 0
    buffer_load_dwordx4 v1, s[8:11], s6 offen sc1 lds
    buffer_load_dwordx4 v1, s[8:11], s6 offen offset:1024 sc1 lds
    s_add_u32 m0, s35, 83968
    s_nop 0
    buffer_load_dwordx4 v1, s[12:15], s6 offen sc1 lds
    buffer_load_dwordx4 v1, s[12:15], s6 offen offset:1024 sc1 lds
    s_min_u32 m0, s66, 156672
    s_add_u32 s66, s66, 1024
    buffer_load_dwordx4 v8, s[20:23], s64 offen lds
    s_add_u32 s64, s64, 7168
    s_min_u32 m0, s66, 156672
    s_add_u32 s66, s66, 7168
    buffer_load_dwordx4 v8, s[20:23], s64 offen lds
    s_add_u32 s64, s64, 50176
    s_lshl_b32 s6, s5, 2
    s_add_u32 s6, s6, 0
    s_cmp_lt_u32 s6, 98
    s_cselect_b32 s26, 64, 0
    s_cmp_eq_u32 s58, 0
    s_cselect_b32 s26, s26, 0
    s_min_u32 s6, s6, 97
    s_cmp_ge_u32 s6, 49
    s_cselect_b32 s24, s46, s44
    s_cselect_b32 s25, s47, s45
    s_cselect_b32 s7, 49, 0
    s_sub_u32 s7, s6, s7
    s_mul_i32 s6, s7, 9363
    s_lshr_b32 s6, s6, 16
    s_mul_i32 s56, s6, 7
    s_sub_u32 s7, s7, s56
    s_and_b32 s56, s4, 3
    s_mul_i32 s56, s56, 7
    s_add_u32 s7, s7, s56
    s_lshl_b32 s7, s7, 7
    s_mul_i32 s6, s6, 229376
    s_add_u32 s6, s6, s7
    s_add_u32 s24, s24, s6
    s_addc_u32 s25, s25, 0xe000000
    s_mov_b32 s27, 0x20000
    buffer_load_dword v7, v0, s[24:27], 0 idxen
    s_waitcnt vmcnt(3)
    s_barrier
    s_add_u32 s6, s34, 49152
    s_add_u32 m0, s35, 0
    s_nop 0
    buffer_load_dwordx4 v1, s[8:11], s6 offen sc1 lds
    buffer_load_dwordx4 v1, s[8:11], s6 offen offset:1024 sc1 lds
    s_add_u32 m0, s35, 2048
    s_nop 0
    buffer_load_dwordx4 v1, s[12:15], s6 offen sc1 lds
    buffer_load_dwordx4 v1, s[12:15], s6 offen offset:1024 sc1 lds
    s_add_u32 s6, s34, 114688
    s_add_u32 m0, s35, 16384
    s_nop 0
    buffer_load_dwordx4 v1, s[8:11], s6 offen sc1 lds
    buffer_load_dwordx4 v1, s[8:11], s6 offen offset:1024 sc1 lds
    s_add_u32 m0, s35, 18432
    s_nop 0
    buffer_load_dwordx4 v1, s[12:15], s6 offen sc1 lds
    buffer_load_dwordx4 v1, s[12:15], s6 offen offset:1024 sc1 lds
    buffer_load_dword v16, v2, s[16:19], 0 offen offset:128 sc1
    s_min_u32 m0, s66, 156672
    s_add_u32 s66, s66, 1024
    buffer_load_dwordx4 v8, s[20:23], s64 offen lds
    s_add_u32 s64, s64, 7168
    s_min_u32 m0, s66, 156672
    s_add_u32 s66, s66, 7168
    buffer_load_dwordx4 v8, s[20:23], s64 offen lds
    s_add_u32 s64, s64, 50176
    s_lshl_b32 s6, s5, 2
    s_add_u32 s6, s6, 1
    s_cmp_lt_u32 s6, 98
    s_cselect_b32 s26, 64, 0
    s_cmp_eq_u32 s58, 1
    s_cselect_b32 s26, s26, 0
    s_min_u32 s6, s6, 97
    s_cmp_ge_u32 s6, 49
    s_cselect_b32 s24, s46, s44
    s_cselect_b32 s25, s47, s45
    s_cselect_b32 s7, 49, 0
    s_sub_u32 s7, s6, s7
    s_mul_i32 s6, s7, 9363
    s_lshr_b32 s6, s6, 16
    s_mul_i32 s56, s6, 7
    s_sub_u32 s7, s7, s56
    s_and_b32 s56, s4, 3
    s_mul_i32 s56, s56, 7
    s_add_u32 s7, s7, s56
    s_lshl_b32 s7, s7, 7
    s_mul_i32 s6, s6, 229376
    s_add_u32 s6, s6, s7
    s_add_u32 s24, s24, s6
    s_addc_u32 s25, s25, 0xe000000
    s_mov_b32 s27, 0x20000
    buffer_load_dword v7, v0, s[24:27], 0 idxen
    s_waitcnt vmcnt(4)
    s_barrier
    s_add_u32 s6, s34, 57344
    s_add_u32 m0, s35, 32768
    s_nop 0
    buffer_load_dwordx4 v1, s[8:11], s6 offen sc1 lds
    buffer_load_dwordx4 v1, s[8:11], s6 offen offset:1024 sc1 lds
    s_add_u32 m0, s35, 34816
    s_nop 0
    buffer_load_dwordx4 v1, s[12:15], s6 offen sc1 lds
    buffer_load_dwordx4 v1, s[12:15], s6 offen offset:1024 sc1 lds
    s_add_u32 s6, s34, 122880
    s_add_u32 m0, s35, 49152
    s_nop 0
    buffer_load_dwordx4 v1, s[8:11], s6 offen sc1 lds
    buffer_load_dwordx4 v1, s[8:11], s6 offen offset:1024 sc1 lds
    s_add_u32 m0, s35, 51200
    s_nop 0
    buffer_load_dwordx4 v1, s[12:15], s6 offen sc1 lds
    buffer_load_dwordx4 v1, s[12:15], s6 offen offset:1024 sc1 lds
    s_min_u32 m0, s66, 156672
    s_add_u32 s66, s66, 1024
    buffer_load_dwordx4 v8, s[20:23], s64 offen lds
    s_add_u32 s64, s64, 7168
    s_min_u32 m0, s66, 156672
    s_add_u32 s66, s66, 7168
    buffer_load_dwordx4 v8, s[20:23], s64 offen lds
    s_add_u32 s64, s64, 50176
    s_lshl_b32 s6, s5, 2
    s_add_u32 s6, s6, 2
    s_cmp_lt_u32 s6, 98
    s_cselect_b32 s26, 64, 0
    s_cmp_eq_u32 s58, 2
    s_cselect_b32 s26, s26, 0
    s_min_u32 s6, s6, 97
    s_cmp_ge_u32 s6, 49
    s_cselect_b32 s24, s46, s44
    s_cselect_b32 s25, s47, s45
    s_cselect_b32 s7, 49, 0
    s_sub_u32 s7, s6, s7
    s_mul_i32 s6, s7, 9363
    s_lshr_b32 s6, s6, 16
    s_mul_i32 s56, s6, 7
    s_sub_u32 s7, s7, s56
    s_and_b32 s56, s4, 3
    s_mul_i32 s56, s56, 7
    s_add_u32 s7, s7, s56
    s_lshl_b32 s7, s7, 7
    s_mul_i32 s6, s6, 229376
    s_add_u32 s6, s6, s7
    s_add_u32 s24, s24, s6
    s_addc_u32 s25, s25, 0xe000000
    s_mov_b32 s27, 0x20000
    buffer_load_dword v7, v0, s[24:27], 0 idxen
    s_mul_i32 s6, s58, 401408
    s_min_u32 s7, s5, 27
    s_lshl_b32 s7, s7, 13
    s_add_u32 s6, s6, s7
    s_add_u32 s6, s6, 172032
    s_add_u32 s24, s48, s6
    s_addc_u32 s25, s49, 0x800000
    s_cmp_lt_u32 s5, 28
    s_cselect_b32 s26, 64, 0
    s_mov_b32 s27, 0x20000
    buffer_load_dword v7, v0, s[24:27], 0 idxen
    s_waitcnt vmcnt(4)
    s_cmp_lg_u32 s3, 11
    s_cbranch_scc1 ld_fl
    s_waitcnt vmcnt(15)
    v_cmp_ne_u32 vcc, 0, v16
    s_nop 0
    s_cbranch_vccnz ld_fl2
    s_mov_b32 s59, 0
ld_fl1:
    buffer_load_dword v16, v2, s[16:19], 0 offen offset:128 sc1
    s_add_u32 s59, s59, 1
    s_cmp_gt_u32 s59, 0x100000
    s_cbranch_scc1 ld_fl2
    s_waitcnt vmcnt(0)
    v_cmp_eq_u32 vcc, 0, v16
    s_nop 0
    s_cbranch_vccnz ld_fl1
ld_fl2:
    v_and_b32 v16, 4, v16
    v_mov_b32 v17, 163824
    ds_write_b32 v17, v16
    s_waitcnt lgkmcnt(0)
ld_fl:
    s_barrier
    s_min_u32 m0, s66, 156672
    s_add_u32 s66, s66, 1024
    buffer_load_dwordx4 v8, s[20:23], s64 offen lds
    s_add_u32 s64, s64, 7168
    s_min_u32 m0, s66, 156672
    s_add_u32 s66, s66, 7168
    buffer_load_dwordx4 v8, s[20:23], s64 offen lds
    s_add_u32 s64, s64, 50176
    s_lshl_b32 s6, s5, 2
    s_add_u32 s6, s6, 3
    s_cmp_lt_u32 s6, 98
    s_cselect_b32 s26, 64, 0
    s_cmp_eq_u32 s58, 3
    s_cselect_b32 s26, s26, 0
    s_min_u32 s6, s6, 97
    s_cmp_ge_u32 s6, 49
    s_cselect_b32 s24, s46, s44
    s_cselect_b32 s25, s47, s45
    s_cselect_b32 s7, 49, 0
    s_sub_u32 s7, s6, s7
    s_mul_i32 s6, s7, 9363
    s_lshr_b32 s6, s6, 16
    s_mul_i32 s56, s6, 7
    s_sub_u32 s7, s7, s56
    s_and_b32 s56, s4, 3
    s_mul_i32 s56, s56, 7
    s_add_u32 s7, s7, s56
    s_lshl_b32 s7, s7, 7
    s_mul_i32 s6, s6, 229376
    s_add_u32 s6, s6, s7
    s_add_u32 s24, s24, s6
    s_addc_u32 s25, s25, 0xe000000
    s_mov_b32 s27, 0x20000
    buffer_load_dword v7, v0, s[24:27], 0 idxen
    s_mul_i32 s6, s58, 401408
    s_min_u32 s7, s5, 20
    s_lshl_b32 s7, s7, 13
    s_add_u32 s6, s6, s7
    s_add_u32 s6, s6, 0
    s_add_u32 s24, s48, s6
    s_addc_u32 s25, s49, 0x800000
    s_cmp_lt_u32 s5, 21
    s_cselect_b32 s26, 64, 0
    s_mov_b32 s27, 0x20000
    buffer_load_dword v7, v0, s[24:27], 0 idxen
    s_barrier
    v_mov_b32 v4, 163824
    ds_read_b32 v4, v4
    s_waitcnt lgkmcnt(0)
    v_readfirstlane_b32 s88, v4
    s_add_u32 s89, s54, 0xa90000
    s_lshr_b32 s89, s89, 19
    s_xor_b32 s89, s89, s4
    s_xor_b32 s89, s89, s88
    s_and_b32 s89, s89, 4
    s_lshl_b32 s89, s89, 11
    s_and_b32 s6, s4, 3
    s_lshl_b32 s6, s6, 2
    s_and_b32 s7, s5, 3
    s_add_u32 s72, s6, s7
    s_lshr_b32 s6, s4, 2
    s_lshl_b32 s6, s6, 3
    s_lshr_b32 s7, s5, 2
    s_add_u32 s73, s6, s7
    s_cmp_ge_u32 s58, 2
    s_cselect_b32 s24, s46, s44
    s_cselect_b32 s25, s47, s45
    s_cselect_b32 s75, 14464, 0
    s_mov_b32 s26, 1605632
    s_mov_b32 s27, 0x20000
    s_and_b32 s6, s58, 1
    s_mul_i32 s7, s6, 7168
    s_add_u32 s75, s75, s7
    s_mul_i32 s6, s6, 448
    s_mul_i32 s7, s72, 224
    v_add_u32 v4, s6, v0
    v_mul_u32_u24 v5, 37450, v4
    v_lshrrev_b32 v5, 19, v5
    v_mul_u32_u24 v6, 14, v5
    v_sub_u32 v4, v4, v6
    v_mul_u32_u24 v11, 3584, v5
    v_lshl_add_u32 v11, v4, 4, v11
    v_add_u32 v11, s7, v11
    v_add_u32 v4, s6, v0
    v_add_u32 v4, 64, v4
    v_mul_u32_u24 v5, 37450, v4
    v_lshrrev_b32 v5, 19, v5
    v_mul_u32_u24 v6, 14, v5
    v_sub_u32 v4, v4, v6
    v_mul_u32_u24 v12, 3584, v5
    v_lshl_add_u32 v12, v4, 4, v12
    v_add_u32 v12, s7, v12
    v_add_u32 v4, s6, v0
    v_add_u32 v4, 128, v4
    v_mul_u32_u24 v5, 37450, v4
    v_lshrrev_b32 v5, 19, v5
    v_mul_u32_u24 v6, 14, v5
    v_sub_u32 v4, v4, v6
    v_mul_u32_u24 v13, 3584, v5
    v_lshl_add_u32 v13, v4, 4, v13
    v_add_u32 v13, s7, v13
    v_add_u32 v4, s6, v0
    v_add_u32 v4, 192, v4
    v_mul_u32_u24 v5, 37450, v4
    v_lshrrev_b32 v5, 19, v5
    v_mul_u32_u24 v6, 14, v5
    v_sub_u32 v4, v4, v6
    v_mul_u32_u24 v14, 3584, v5
    v_lshl_add_u32 v14, v4, 4, v14
    v_add_u32 v14, s7, v14
    v_add_u32 v4, s6, v0
    v_add_u32 v4, 256, v4
    v_mul_u32_u24 v5, 37450, v4
    v_lshrrev_b32 v5, 19, v5
    v_mul_u32_u24 v6, 14, v5
    v_sub_u32 v4, v4, v6
    v_mul_u32_u24 v15, 3584, v5
    v_lshl_add_u32 v15, v4, 4, v15
    v_add_u32 v15, s7, v15
    v_add_u32 v4, s6, v0
    v_add_u32 v4, 320, v4
    v_mul_u32_u24 v5, 37450, v4
    v_lshrrev_b32 v5, 19, v5
    v_mul_u32_u24 v6, 14, v5
    v_sub_u32 v4, v4, v6
    v_mul_u32_u24 v16, 3584, v5
    v_lshl_add_u32 v16, v4, 4, v16
    v_add_u32 v16, s7, v16
    v_add_u32 v4, s6, v0
    v_add_u32 v4, 384, v4
    v_mul_u32_u24 v5, 37450, v4
    v_lshrrev_b32 v5, 19, v5
    v_mul_u32_u24 v6, 14, v5
    v_sub_u32 v4, v4, v6
    v_mul_u32_u24 v17, 3584, v5
    v_lshl_add_u32 v17, v4, 4, v17
    v_add_u32 v17, s7, v17
    s_lshl_b32 s65, s33, 7
    s_add_u32 s65, s65, 2048
    s_add_u32 s65, s65, s89
    s_barrier
    s_waitcnt vmcnt(1)
    s_barrier
    s_cmp_lg_u32 s3, 8
    s_cbranch_scc1 sig_10
    s_mov_b64 exec, 1
    buffer_atomic_add v3, v2, s[60:63], s65 offen sc1
    s_mov_b64 exec, -1
sig_10:
    s_cmp_ge_u32 s5, 28
    s_cbranch_scc1 ld_cs
    s_mov_b32 s74, 0
    s_add_u32 m0, s75, 0
    s_nop 0
    buffer_load_dwordx4 v11, s[24:27], s74 offen lds
    s_add_u32 m0, s75, 1024
    s_nop 0
    buffer_load_dwordx4 v12, s[24:27], s74 offen lds
    s_add_u32 m0, s75, 2048
    s_nop 0
    buffer_load_dwordx4 v13, s[24:27], s74 offen lds
    s_add_u32 m0, s75, 3072
    s_nop 0
    buffer_load_dwordx4 v14, s[24:27], s74 offen lds
    s_add_u32 m0, s75, 4096
    s_nop 0
    buffer_load_dwordx4 v15, s[24:27], s74 offen lds
    s_add_u32 m0, s75, 5120
    s_nop 0
    buffer_load_dwordx4 v16, s[24:27], s74 offen lds
    s_add_u32 m0, s75, 6144
    s_nop 0
    buffer_load_dwordx4 v17, s[24:27], s74 offen lds
    s_lshr_b32 s6, s76, 1
    s_lshl_b32 s6, s6, 7
    s_add_u32 s6, s6, s89
    s_add_u32 s65, s6, 4096
    s_cmp_lg_u32 s3, 11
    s_cbranch_scc1 ld_w2
    s_add_u32 s6, s6, 2048
    v_mov_b32 v5, s6
    s_mov_b64 exec, 1
    s_mov_b32 s59, 0
    s_sleep 18
poll_11:
    s_sleep 2
    buffer_load_dword v4, v5, s[60:63], 0 offen sc1
    s_add_u32 s59, s59, 1
    s_cmp_gt_u32 s59, 0x100000
    s_cbranch_scc1 polle_12
    s_waitcnt vmcnt(0)
    v_cmp_lt_u32 vcc, v4, v10
    s_nop 0
    s_cbranch_vccnz poll_11
polle_12:
    s_mov_b64 exec, -1
ld_w2:
    s_lshr_b32 s56, s58, 1
    s_lshl_b32 s57, s76, 1
    s_add_u32 s57, s57, s56
    s_add_u32 s8, s54, 0x600000
    s_addc_u32 s9, s55, 0
    s_mov_b32 s10, 0xe000
    s_mov_b32 s11, 0x20000
    s_and_b32 s6, s57, 31
    s_mul_i32 s6, s6, 65536
    s_add_u32 s8, s8, s6
    s_addc_u32 s9, s9, 0
    s_add_u32 s7, s54, 0x600000
    s_add_u32 s7, s7, s6
    s_lshr_b32 s7, s7, 19
    s_xor_b32 s7, s7, s4
    s_xor_b32 s7, s7, s88
    s_and_b32 s7, s7, 4
    s_lshl_b32 s7, s7, 11
    s_add_u32 s8, s8, s7
    s_addc_u32 s9, s9, 0
    s_lshl_b32 s6, s56, 15
    s_and_b32 s57, s58, 1
    s_lshl_b32 s57, s57, 12
    s_add_u32 s6, s6, s57
    s_barrier
    s_add_u32 m0, s6, 32768
    s_add_u32 s7, s57, 0
    buffer_load_dwordx4 v1, s[8:11], s7 offen offset:0 sc1 lds
    buffer_load_dwordx4 v1, s[8:11], s7 offen offset:1024 sc1 lds
    buffer_load_dwordx4 v1, s[8:11], s7 offen offset:2048 sc1 lds
    buffer_load_dwordx4 v1, s[8:11], s7 offen offset:3072 sc1 lds
    s_add_u32 m0, s6, 40960
    s_add_u32 s7, s57, 16384
    buffer_load_dwordx4 v1, s[8:11], s7 offen offset:0 sc1 lds
    buffer_load_dwordx4 v1, s[8:11], s7 offen offset:1024 sc1 lds
    buffer_load_dwordx4 v1, s[8:11], s7 offen offset:2048 sc1 lds
    buffer_load_dwordx4 v1, s[8:11], s7 offen offset:3072 sc1 lds
    s_waitcnt vmcnt(4)
    s_barrier
    s_add_u32 m0, s6, 49152
    s_add_u32 s7, s57, 32768
    buffer_load_dwordx4 v1, s[8:11], s7 offen offset:0 sc1 lds
    buffer_load_dwordx4 v1, s[8:11], s7 offen offset:1024 sc1 lds
    buffer_load_dwordx4 v1, s[8:11], s7 offen offset:2048 sc1 lds
    buffer_load_dwordx4 v1, s[8:11], s7 offen offset:3072 sc1 lds
    s_waitcnt vmcnt(4)
    s_barrier
    s_add_u32 m0, s6, 57344
    s_add_u32 s7, s57, 49152
    buffer_load_dwordx4 v1, s[8:11], s7 offen offset:0 sc1 lds
    buffer_load_dwordx4 v1, s[8:11], s7 offen offset:1024 sc1 lds
    buffer_load_dwordx4 v1, s[8:11], s7 offen offset:2048 sc1 lds
    buffer_load_dwordx4 v1, s[8:11], s7 offen offset:3072 sc1 lds
    s_waitcnt vmcnt(4)
    s_barrier
    s_waitcnt vmcnt(0)
    s_barrier
    s_mov_b32 s74, 688128
    s_add_u32 m0, s75, 98304
    s_nop 0
    buffer_load_dwordx4 v11, s[24:27], s74 offen lds
    s_add_u32 m0, s75, 99328
    s_nop 0
    buffer_load_dwordx4 v12, s[24:27], s74 offen lds
    s_add_u32 m0, s75, 100352
    s_nop 0
    buffer_load_dwordx4 v13, s[24:27], s74 offen lds
    s_add_u32 m0, s75, 101376
    s_nop 0
    buffer_load_dwordx4 v14, s[24:27], s74 offen lds
    s_add_u32 m0, s75, 102400
    s_nop 0
    buffer_load_dwordx4 v15, s[24:27], s74 offen lds
    s_add_u32 m0, s75, 103424
    s_nop 0
    buffer_load_dwordx4 v16, s[24:27], s74 offen lds
    s_add_u32 m0, s75, 104448
    s_nop 0
    buffer_load_dwordx4 v17, s[24:27], s74 offen lds
    s_barrier
    s_cmp_lg_u32 s3, 8
    s_cbranch_scc1 sig_13
    s_mov_b64 exec, 1
    buffer_atomic_add v3, v2, s[60:63], s65 offen sc1
    s_mov_b64 exec, -1
sig_13:
    s_branch ld_p3w
ld_cs:
    s_mov_b32 s65, 16384
    s_barrier
    s_barrier
    s_cmp_lg_u32 s3, 8
    s_cbranch_scc1 sig_14
    s_mov_b64 exec, 1
    buffer_atomic_add v3, v2, s[60:63], s65 offen sc1
    s_mov_b64 exec, -1
sig_14:
    s_mov_b32 s74, 0
    s_add_u32 m0, s75, 0
    s_nop 0
    buffer_load_dwordx4 v11, s[24:27], s74 offen lds
    s_add_u32 m0, s75, 1024
    s_nop 0
    buffer_load_dwordx4 v12, s[24:27], s74 offen lds
    s_add_u32 m0, s75, 2048
    s_nop 0
    buffer_load_dwordx4 v13, s[24:27], s74 offen lds
    s_add_u32 m0, s75, 3072
    s_nop 0
    buffer_load_dwordx4 v14, s[24:27], s74 offen lds
    s_add_u32 m0, s75, 4096
    s_nop 0
    buffer_load_dwordx4 v15, s[24:27], s74 offen lds
    s_add_u32 m0, s75, 5120
    s_nop 0
    buffer_load_dwordx4 v16, s[24:27], s74 offen lds
    s_add_u32 m0, s75, 6144
    s_nop 0
    buffer_load_dwordx4 v17, s[24:27], s74 offen lds
    s_mov_b32 s74, 688128
    s_add_u32 m0, s75, 98304
    s_nop 0
    buffer_load_dwordx4 v11, s[24:27], s74 offen lds
    s_add_u32 m0, s75, 99328
    s_nop 0
    buffer_load_dwordx4 v12, s[24:27], s74 offen lds
    s_add_u32 m0, s75, 100352
    s_nop 0
    buffer_load_dwordx4 v13, s[24:27], s74 offen lds
    s_add_u32 m0, s75, 101376
    s_nop 0
    buffer_load_dwordx4 v14, s[24:27], s74 offen lds
    s_add_u32 m0, s75, 102400
    s_nop 0
    buffer_load_dwordx4 v15, s[24:27], s74 offen lds
    s_add_u32 m0, s75, 103424
    s_nop 0
    buffer_load_dwordx4 v16, s[24:27], s74 offen lds
    s_add_u32 m0, s75, 104448
    s_nop 0
    buffer_load_dwordx4 v17, s[24:27], s74 offen lds
ld_p3w:
    s_mov_b32 s74, 229376
    s_add_u32 m0, s75, 32768
    s_nop 0
    buffer_load_dwordx4 v11, s[24:27], s74 offen lds
    s_add_u32 m0, s75, 33792
    s_nop 0
    buffer_load_dwordx4 v12, s[24:27], s74 offen lds
    s_add_u32 m0, s75, 34816
    s_nop 0
    buffer_load_dwordx4 v13, s[24:27], s74 offen lds
    s_add_u32 m0, s75, 35840
    s_nop 0
    buffer_load_dwordx4 v14, s[24:27], s74 offen lds
    s_add_u32 m0, s75, 36864
    s_nop 0
    buffer_load_dwordx4 v15, s[24:27], s74 offen lds
    s_add_u32 m0, s75, 37888
    s_nop 0
    buffer_load_dwordx4 v16, s[24:27], s74 offen lds
    s_add_u32 m0, s75, 38912
    s_nop 0
    buffer_load_dwordx4 v17, s[24:27], s74 offen lds
    s_mov_b32 s74, 458752
    s_add_u32 m0, s75, 65536
    s_nop 0
    buffer_load_dwordx4 v11, s[24:27], s74 offen lds
    s_add_u32 m0, s75, 66560
    s_nop 0
    buffer_load_dwordx4 v12, s[24:27], s74 offen lds
    s_add_u32 m0, s75, 67584
    s_nop 0
    buffer_load_dwordx4 v13, s[24:27], s74 offen lds
    s_add_u32 m0, s75, 68608
    s_nop 0
    buffer_load_dwordx4 v14, s[24:27], s74 offen lds
    s_add_u32 m0, s75, 69632
    s_nop 0
    buffer_load_dwordx4 v15, s[24:27], s74 offen lds
    s_add_u32 m0, s75, 70656
    s_nop 0
    buffer_load_dwordx4 v16, s[24:27], s74 offen lds
    s_add_u32 m0, s75, 71680
    s_nop 0
    buffer_load_dwordx4 v17, s[24:27], s74 offen lds
    s_lshl_b32 s32, s73, 2
    s_add_u32 s32, s32, s58
    s_lshl_b32 s33, s58, 12
    s_add_u32 s8, s54, 0x800000
    s_addc_u32 s9, s55, 0
    s_mov_b32 s10, 0xe000
    s_mov_b32 s11, 0x20000
    s_and_b32 s6, s32, 31
    s_mul_i32 s6, s6, 65536
    s_add_u32 s8, s8, s6
    s_addc_u32 s9, s9, 0
    s_add_u32 s7, s54, 0x800000
    s_add_u32 s7, s7, s6
    s_lshr_b32 s7, s7, 19
    s_xor_b32 s7, s7, s4
    s_xor_b32 s7, s7, s88
    s_and_b32 s7, s7, 4
    s_lshl_b32 s7, s7, 11
    s_add_u32 s8, s8, s7
    s_addc_u32 s9, s9, 0
    s_add_u32 s12, s54, 0xa80000
    s_addc_u32 s13, s55, 0
    s_mov_b32 s14, 0x3800
    s_mov_b32 s15, 0x20000
    s_add_u32 s20, s54, 0xa00000
    s_addc_u32 s21, s55, 0
    s_mov_b32 s22, 0xe00
    s_mov_b32 s23, 0x20000
    s_and_b32 s6, s32, 31
    s_and_b32 s7, s6, 1
    s_lshl_b32 s7, s7, 12
    s_lshr_b32 s6, s6, 1
    s_lshl_b32 s6, s6, 14
    s_add_u32 s6, s6, s7
    s_add_u32 s20, s20, s6
    s_addc_u32 s21, s21, 0
    s_add_u32 s7, s54, 0xa00000
    s_add_u32 s7, s7, s6
    s_lshr_b32 s7, s7, 19
    s_xor_b32 s7, s7, s4
    s_xor_b32 s7, s7, s88
    s_and_b32 s7, s7, 4
    s_lshl_b32 s7, s7, 11
    s_add_u32 s20, s20, s7
    s_addc_u32 s21, s21, 0
    s_lshl_b32 s6, s58, 9
    s_add_u32 s6, s6, 95232
    v_and_b32 v4, 31, v0
    v_lshl_add_u32 v19, v4, 4, s6
    v_lshrrev_b32 v5, 5, v0
    v_mul_u32_u24 v8, 1792, v5
    v_lshl_add_u32 v8, v4, 3, v8
    s_and_b32 s56, s72, 3
    s_lshl_b32 s7, s73, 2
    s_add_u32 s56, s56, s7
    s_add_u32 s16, s54, 0x800000
    s_addc_u32 s17, s55, 0
    s_mov_b32 s18, 0x0
    s_mov_b32 s19, 0x20000
    s_and_b32 s6, s56, 31
    s_mul_i32 s6, s6, 65536
    s_add_u32 s16, s16, s6
    s_addc_u32 s17, s17, 0
    s_add_u32 s7, s54, 0x800000
    s_add_u32 s7, s7, s6
    s_lshr_b32 s7, s7, 19
    s_xor_b32 s7, s7, s4
    s_xor_b32 s7, s7, s88
    s_and_b32 s7, s7, 4
    s_lshl_b32 s7, s7, 11
    s_add_u32 s16, s16, s7
    s_addc_u32 s17, s17, 0
    s_lshl_b32 s7, s58, 14
    s_add_u32 s7, s7, 16384
    s_add_u32 s16, s16, s7
    s_addc_u32 s17, s17, 0x800000
    s_cmp_lt_u32 s58, 2
    s_cselect_b32 s18, 64, 0
    s_cmp_eq_u32 s58, 2
    s_cselect_b32 s18, 32, s18
    s_mov_b32 s19, 0x20000
    v_lshrrev_b32 v4, 3, v0
    v_lshlrev_b32 v9, 6, v4
    v_bfe_u32 v4, v0, 2, 1
    v_mul_u32_u24 v4, 7168, v4
    v_and_b32 v5, 3, v0
    v_lshlrev_b32 v5, 4, v5
    v_add3_u32 v9, v9, v4, v5
    s_mul_i32 s6, s72, 448
    v_add_u32 v9, s6, v9
    s_lshl_b32 s7, s77, 7
    v_lshrrev_b32 v4, 3, v0
    v_mul_u32_u24 v18, 896, v4
    v_bfe_u32 v4, v0, 4, 1
    v_lshlrev_b32 v4, 2, v4
    v_and_b32 v5, 7, v0
    v_xor_b32 v4, v4, v5
    v_lshl_add_u32 v18, v4, 4, v18
    v_add_u32 v18, s7, v18
    s_mov_b32 s28, s48
    s_mov_b32 s29, s49
    s_mov_b32 s30, 0x188000
    s_mov_b32 s31, 0x20000
    s_cmp_lt_u32 s5, 28
    s_cselect_b32 s30, s30, 0
    s_mov_b32 s78, 0
    s_lshl_b32 s79, s58, 13
    s_mul_i32 s80, s58, 401408
    s_lshl_b32 s6, s73, 7
    s_add_u32 s6, s6, s89
    s_add_u32 s65, s6, 6144
    s_cmp_lg_u32 s3, 11
    s_cbranch_scc1 ld_w3
    s_add_u32 s6, s6, 4096
    v_mov_b32 v4, s6
    v_mov_b32 v5, 14
    v_cmp_eq_u32 vcc, 1, v0
    v_mov_b32 v6, 16384
    s_nop 0
    v_cndmask_b32 v4, v4, v6, vcc
    v_mov_b32 v6, 32
    v_cndmask_b32 v5, v5, v6, vcc
    s_mov_b64 exec, 3
    s_mov_b32 s59, 0
poll_15:
    s_sleep 2
    buffer_load_dword v6, v4, s[60:63], 0 offen sc1
    s_add_u32 s59, s59, 1
    s_cmp_gt_u32 s59, 0x100000
    s_cbranch_scc1 polle_16
    s_waitcnt vmcnt(0)
    v_cmp_lt_u32 vcc, v6, v5
    s_nop 0
    s_cbranch_vccnz poll_15
polle_16:
    s_mov_b64 exec, -1
ld_w3:
    s_barrier
    s_add_u32 m0, s33, 131072
    s_mov_b32 s6, 0
    buffer_load_dwordx4 v1, s[8:11], s6 offen offset:0 sc1 lds
    buffer_load_dwordx4 v1, s[8:11], s6 offen offset:1024 sc1 lds
    buffer_load_dwordx4 v1, s[8:11], s6 offen offset:2048 sc1 lds
    buffer_load_dwordx4 v1, s[8:11], s6 offen offset:3072 sc1 lds
    s_add_u32 m0, s33, 147456
    s_mov_b32 s6, 4096
    buffer_load_dwordx4 v1, s[8:11], s6 offen offset:0 sc1 lds
    buffer_load_dwordx4 v1, s[8:11], s6 offen offset:1024 sc1 lds
    buffer_load_dwordx4 v1, s[8:11], s6 offen offset:2048 sc1 lds
    buffer_load_dwordx4 v1, s[8:11], s6 offen offset:3072 sc1 lds
    s_waitcnt vmcnt(4) lgkmcnt(0)
    s_barrier
    buffer_load_dword v7, v0, s[16:19], 0 idxen sc1
    s_mov_b32 m0, 94336
    s_mov_b32 exec_hi, 0xffffff
    buffer_load_dwordx4 v9, s[12:15], 0 offen sc1 lds
    s_mov_b32 exec_hi, -1
    buffer_load_dwordx2 v[20:21], v8, s[20:23], 0 offen offset:0 sc1
    buffer_load_dwordx2 v[22:23], v8, s[20:23], 0 offen offset:256 sc1
    buffer_load_dwordx2 v[24:25], v8, s[20:23], 0 offen offset:512 sc1
    buffer_load_dwordx2 v[26:27], v8, s[20:23], 0 offen offset:768 sc1
    buffer_load_dwordx2 v[28:29], v8, s[20:23], 0 offen offset:1024 sc1
    buffer_load_dwordx2 v[30:31], v8, s[20:23], 0 offen offset:1280 sc1
    buffer_load_dwordx2 v[32:33], v8, s[20:23], 0 offen offset:1536 sc1
    s_waitcnt vmcnt(9) lgkmcnt(0)
    s_barrier
    s_add_u32 m0, s33, 131072
    s_mov_b32 s6, 16384
    buffer_load_dwordx4 v1, s[8:11], s6 offen offset:0 sc1 lds
    buffer_load_dwordx4 v1, s[8:11], s6 offen offset:1024 sc1 lds
    buffer_load_dwordx4 v1, s[8:11], s6 offen offset:2048 sc1 lds
    buffer_load_dwordx4 v1, s[8:11], s6 offen offset:3072 sc1 lds
    s_mov_b32 s74, 917504
    s_add_u32 m0, s75, 0
    s_nop 0
    buffer_load_dwordx4 v11, s[24:27], s74 offen lds
    s_add_u32 m0, s75, 1024
    s_nop 0
    buffer_load_dwordx4 v12, s[24:27], s74 offen lds
    s_add_u32 m0, s75, 2048
    s_nop 0
    buffer_load_dwordx4 v13, s[24:27], s74 offen lds
    s_add_u32 m0, s75, 3072
    s_nop 0
    buffer_load_dwordx4 v14, s[24:27], s74 offen lds
    s_add_u32 m0, s75, 4096
    s_nop 0
    buffer_load_dwordx4 v15, s[24:27], s74 offen lds
    s_add_u32 m0, s75, 5120
    s_nop 0
    buffer_load_dwordx4 v16, s[24:27], s74 offen lds
    s_add_u32 m0, s75, 6144
    s_nop 0
    buffer_load_dwordx4 v17, s[24:27], s74 offen lds
    s_waitcnt vmcnt(7) lgkmcnt(0)
    s_barrier
    s_add_u32 m0, s33, 147456
    s_mov_b32 s6, 20480
    buffer_load_dwordx4 v1, s[8:11], s6 offen offset:0 sc1 lds
    buffer_load_dwordx4 v1, s[8:11], s6 offen offset:1024 sc1 lds
    buffer_load_dwordx4 v1, s[8:11], s6 offen offset:2048 sc1 lds
    buffer_load_dwordx4 v1, s[8:11], s6 offen offset:3072 sc1 lds
    s_mov_b32 s74, 1146880
    s_add_u32 m0, s75, 32768
    s_nop 0
    buffer_load_dwordx4 v11, s[24:27], s74 offen lds
    s_add_u32 m0, s75, 33792
    s_nop 0
    buffer_load_dwordx4 v12, s[24:27], s74 offen lds
    s_add_u32 m0, s75, 34816
    s_nop 0
    buffer_load_dwordx4 v13, s[24:27], s74 offen lds
    s_add_u32 m0, s75, 35840
    s_nop 0
    buffer_load_dwordx4 v14, s[24:27], s74 offen lds
    s_add_u32 m0, s75, 36864
    s_nop 0
    buffer_load_dwordx4 v15, s[24:27], s74 offen lds
    s_add_u32 m0, s75, 37888
    s_nop 0
    buffer_load_dwordx4 v16, s[24:27], s74 offen lds
    s_add_u32 m0, s75, 38912
    s_nop 0
    buffer_load_dwordx4 v17, s[24:27], s74 offen lds
    s_waitcnt vmcnt(7) lgkmcnt(0)
    s_barrier
    s_add_u32 m0, s33, 131072
    s_mov_b32 s6, 32768
    buffer_load_dwordx4 v1, s[8:11], s6 offen offset:0 sc1 lds
    buffer_load_dwordx4 v1, s[8:11], s6 offen offset:1024 sc1 lds
    buffer_load_dwordx4 v1, s[8:11], s6 offen offset:2048 sc1 lds
    buffer_load_dwordx4 v1, s[8:11], s6 offen offset:3072 sc1 lds
    s_mov_b32 s74, 1376256
    s_add_u32 m0, s75, 65536
    s_nop 0
    buffer_load_dwordx4 v11, s[24:27], s74 offen lds
    s_add_u32 m0, s75, 66560
    s_nop 0
    buffer_load_dwordx4 v12, s[24:27], s74 offen lds
    s_add_u32 m0, s75, 67584
    s_nop 0
    buffer_load_dwordx4 v13, s[24:27], s74 offen lds
    s_add_u32 m0, s75, 68608
    s_nop 0
    buffer_load_dwordx4 v14, s[24:27], s74 offen lds
    s_add_u32 m0, s75, 69632
    s_nop 0
    buffer_load_dwordx4 v15, s[24:27], s74 offen lds
    s_add_u32 m0, s75, 70656
    s_nop 0
    buffer_load_dwordx4 v16, s[24:27], s74 offen lds
    s_add_u32 m0, s75, 71680
    s_nop 0
    buffer_load_dwordx4 v17, s[24:27], s74 offen lds
    s_waitcnt vmcnt(7) lgkmcnt(0)
    s_barrier
    s_add_u32 m0, s33, 98304
    s_mov_b32 s6, 36864
    buffer_load_dwordx4 v1, s[8:11], s6 offen offset:0 sc1 lds
    buffer_load_dwordx4 v1, s[8:11], s6 offen offset:1024 sc1 lds
    buffer_load_dwordx4 v1, s[8:11], s6 offen offset:2048 sc1 lds
    buffer_load_dwordx4 v1, s[8:11], s6 offen offset:3072 sc1 lds
    s_add_u32 m0, s33, 114688
    s_mov_b32 s6, 49152
    buffer_load_dwordx4 v1, s[8:11], s6 offen offset:0 sc1 lds
    buffer_load_dwordx4 v1, s[8:11], s6 offen offset:1024 sc1 lds
    buffer_load_dwordx4 v1, s[8:11], s6 offen offset:2048 sc1 lds
    buffer_load_dwordx4 v1, s[8:11], s6 offen offset:3072 sc1 lds
    s_waitcnt vmcnt(41)
    v_add_f32 v20, v20, v28
    v_add_f32 v21, v21, v29
    v_add_f32 v22, v22, v30
    v_add_f32 v23, v23, v31
    v_add_f32 v24, v24, v32
    v_add_f32 v25, v25, v33
    v_add_f32 v20, v20, v24
    v_add_f32 v21, v21, v25
    v_add_f32 v22, v22, v26
    v_add_f32 v23, v23, v27
    v_add_f32 v20, v20, v22
    v_add_f32 v21, v21, v23
    v_mov_b32 v22, v20
    v_mov_b32 v23, v21
    s_nop 0
    v_permlane32_swap_b32 v22, v20
    v_permlane32_swap_b32 v23, v21
    s_waitcnt vmcnt(4) lgkmcnt(0)
    s_barrier
    v_add_f32 v20, v20, v22
    v_add_f32 v21, v21, v23
    v_mul_f32 v20, 0xbb124925, v20
    v_mul_f32 v22, 0x3b124925, v21
    v_fma_f32 v22, -v20, v20, v22
    v_max_f32 v22, 0, v22
    v_add_f32 v22, 0x3727c5ac, v22
    v_rsq_f32 v21, v22
    s_nop 0
    v_mul_f32 v21, 0xbfb8aa3b, v21
    ds_write_b128 v19, v[20:23]
    s_waitcnt vmcnt(0) lgkmcnt(0)
    s_barrier
    s_mul_i32 s81, s78, 57344
    s_add_u32 s81, s81, s80
    s_add_u32 m0, s79, 131072
    s_nop 0
    buffer_load_dwordx4 v18, s[28:31], s81 offen lds
    s_add_u32 m0, s79, 132096
    s_add_u32 s81, s81, 7168
    buffer_load_dwordx4 v18, s[28:31], s81 offen lds
    s_add_u32 m0, s79, 133120
    s_add_u32 s81, s81, 7168
    buffer_load_dwordx4 v18, s[28:31], s81 offen lds
    s_add_u32 m0, s79, 134144
    s_add_u32 s81, s81, 7168
    buffer_load_dwordx4 v18, s[28:31], s81 offen lds
    s_add_u32 m0, s79, 135168
    s_add_u32 s81, s81, 7168
    buffer_load_dwordx4 v18, s[28:31], s81 offen lds
    s_add_u32 m0, s79, 136192
    s_add_u32 s81, s81, 7168
    buffer_load_dwordx4 v18, s[28:31], s81 offen lds
    s_add_u32 m0, s79, 137216
    s_add_u32 s81, s81, 7168
    buffer_load_dwordx4 v18, s[28:31], s81 offen lds
    s_add_u32 m0, s79, 138240
    s_add_u32 s81, s81, 7168
    buffer_load_dwordx4 v18, s[28:31], s81 offen lds
    s_add_u32 s78, s78, 1
    s_cmp_eq_u32 s78, 7
    s_cselect_b32 s78, 0, s78
    s_mul_i32 s81, s78, 57344
    s_add_u32 s81, s81, s80
    s_add_u32 m0, s79, 0
    s_nop 0
    buffer_load_dwordx4 v18, s[28:31], s81 offen lds
    s_add_u32 m0, s79, 1024
    s_add_u32 s81, s81, 7168
    buffer_load_dwordx4 v18, s[28:31], s81 offen lds
    s_add_u32 m0, s79, 2048
    s_add_u32 s81, s81, 7168
    buffer_load_dwordx4 v18, s[28:31], s81 offen lds
    s_add_u32 m0, s79, 3072
    s_add_u32 s81, s81, 7168
    buffer_load_dwordx4 v18, s[28:31], s81 offen lds
    s_add_u32 m0, s79, 4096
    s_add_u32 s81, s81, 7168
    buffer_load_dwordx4 v18, s[28:31], s81 offen lds
    s_add_u32 m0, s79, 5120
    s_add_u32 s81, s81, 7168
    buffer_load_dwordx4 v18, s[28:31], s81 offen lds
    s_add_u32 m0, s79, 6144
    s_add_u32 s81, s81, 7168
    buffer_load_dwordx4 v18, s[28:31], s81 offen lds
    s_add_u32 m0, s79, 7168
    s_add_u32 s81, s81, 7168
    buffer_load_dwordx4 v18, s[28:31], s81 offen lds
    s_add_u32 s78, s78, 1
    s_cmp_eq_u32 s78, 7
    s_cselect_b32 s78, 0, s78
    s_mul_i32 s81, s78, 57344
    s_add_u32 s81, s81, s80
    s_add_u32 m0, s79, 32768
    s_nop 0
    buffer_load_dwordx4 v18, s[28:31], s81 offen lds
    s_add_u32 m0, s79, 33792
    s_add_u32 s81, s81, 7168
    buffer_load_dwordx4 v18, s[28:31], s81 offen lds
    s_add_u32 m0, s79, 34816
    s_add_u32 s81, s81, 7168
    buffer_load_dwordx4 v18, s[28:31], s81 offen lds
    s_add_u32 m0, s79, 35840
    s_add_u32 s81, s81, 7168
    buffer_load_dwordx4 v18, s[28:31], s81 offen lds
    s_add_u32 m0, s79, 36864
    s_add_u32 s81, s81, 7168
    buffer_load_dwordx4 v18, s[28:31], s81 offen lds
    s_add_u32 m0, s79, 37888
    s_add_u32 s81, s81, 7168
    buffer_load_dwordx4 v18, s[28:31], s81 offen lds
    s_add_u32 m0, s79, 38912
    s_add_u32 s81, s81, 7168
    buffer_load_dwordx4 v18, s[28:31], s81 offen lds
    s_add_u32 m0, s79, 39936
    s_add_u32 s81, s81, 7168
    buffer_load_dwordx4 v18, s[28:31], s81 offen lds
    s_add_u32 s78, s78, 1
    s_cmp_eq_u32 s78, 7
    s_cselect_b32 s78, 0, s78
    s_waitcnt vmcnt(0)
    s_barrier
    s_cmp_lg_u32 s3, 8
    s_cbranch_scc1 sig_17
    s_mov_b64 exec, 1
    buffer_atomic_add v3, v2, s[60:63], s65 offen sc1
    s_mov_b64 exec, -1
sig_17:
    s_cmp_ge_u32 s5, 28
    s_cbranch_scc1 all_done
    s_mul_i32 s81, s78, 57344
    s_add_u32 s81, s81, s80
    s_add_u32 m0, s79, 65536
    s_nop 0
    buffer_load_dwordx4 v18, s[28:31], s81 offen lds
    s_add_u32 m0, s79, 66560
    s_add_u32 s81, s81, 7168
    buffer_load_dwordx4 v18, s[28:31], s81 offen lds
    s_add_u32 m0, s79, 67584
    s_add_u32 s81, s81, 7168
    buffer_load_dwordx4 v18, s[28:31], s81 offen lds
    s_add_u32 m0, s79, 68608
    s_add_u32 s81, s81, 7168
    buffer_load_dwordx4 v18, s[28:31], s81 offen lds
    s_add_u32 m0, s79, 69632
    s_add_u32 s81, s81, 7168
    buffer_load_dwordx4 v18, s[28:31], s81 offen lds
    s_add_u32 m0, s79, 70656
    s_add_u32 s81, s81, 7168
    buffer_load_dwordx4 v18, s[28:31], s81 offen lds
    s_add_u32 m0, s79, 71680
    s_add_u32 s81, s81, 7168
    buffer_load_dwordx4 v18, s[28:31], s81 offen lds
    s_add_u32 m0, s79, 72704
    s_add_u32 s81, s81, 7168
    buffer_load_dwordx4 v18, s[28:31], s81 offen lds
    s_add_u32 s78, s78, 1
    s_cmp_eq_u32 s78, 7
    s_cselect_b32 s78, 0, s78
    s_mul_i32 s81, s78, 57344
    s_add_u32 s81, s81, s80
    s_add_u32 m0, s79, 98304
    s_nop 0
    buffer_load_dwordx4 v18, s[28:31], s81 offen lds
    s_add_u32 m0, s79, 99328
    s_add_u32 s81, s81, 7168
    buffer_load_dwordx4 v18, s[28:31], s81 offen lds
    s_add_u32 m0, s79, 100352
    s_add_u32 s81, s81, 7168
    buffer_load_dwordx4 v18, s[28:31], s81 offen lds
    s_add_u32 m0, s79, 101376
    s_add_u32 s81, s81, 7168
    buffer_load_dwordx4 v18, s[28:31], s81 offen lds
    s_add_u32 m0, s79, 102400
    s_add_u32 s81, s81, 7168
    buffer_load_dwordx4 v18, s[28:31], s81 offen lds
    s_add_u32 m0, s79, 103424
    s_add_u32 s81, s81, 7168
    buffer_load_dwordx4 v18, s[28:31], s81 offen lds
    s_add_u32 m0, s79, 104448
    s_add_u32 s81, s81, 7168
    buffer_load_dwordx4 v18, s[28:31], s81 offen lds
    s_add_u32 m0, s79, 105472
    s_add_u32 s81, s81, 7168
    buffer_load_dwordx4 v18, s[28:31], s81 offen lds
    s_add_u32 s78, s78, 1
    s_cmp_eq_u32 s78, 7
    s_cselect_b32 s78, 0, s78
    s_barrier
    s_mul_i32 s81, s78, 57344
    s_add_u32 s81, s81, s80
    s_add_u32 m0, s79, 131072
    s_nop 0
    buffer_load_dwordx4 v18, s[28:31], s81 offen lds
    s_add_u32 m0, s79, 132096
    s_add_u32 s81, s81, 7168
    buffer_load_dwordx4 v18, s[28:31], s81 offen lds
    s_add_u32 m0, s79, 133120
    s_add_u32 s81, s81, 7168
    buffer_load_dwordx4 v18, s[28:31], s81 offen lds
    s_add_u32 m0, s79, 134144
    s_add_u32 s81, s81, 7168
    buffer_load_dwordx4 v18, s[28:31], s81 offen lds
    s_add_u32 m0, s79, 135168
    s_add_u32 s81, s81, 7168
    buffer_load_dwordx4 v18, s[28:31], s81 offen lds
    s_add_u32 m0, s79, 136192
    s_add_u32 s81, s81, 7168
    buffer_load_dwordx4 v18, s[28:31], s81 offen lds
    s_add_u32 m0, s79, 137216
    s_add_u32 s81, s81, 7168
    buffer_load_dwordx4 v18, s[28:31], s81 offen lds
    s_add_u32 m0, s79, 138240
    s_add_u32 s81, s81, 7168
    buffer_load_dwordx4 v18, s[28:31], s81 offen lds
    s_add_u32 s78, s78, 1
    s_cmp_eq_u32 s78, 7
    s_cselect_b32 s78, 0, s78
    s_mul_i32 s81, s78, 57344
    s_add_u32 s81, s81, s80
    s_add_u32 m0, s79, 0
    s_nop 0
    buffer_load_dwordx4 v18, s[28:31], s81 offen lds
    s_add_u32 m0, s79, 1024
    s_add_u32 s81, s81, 7168
    buffer_load_dwordx4 v18, s[28:31], s81 offen lds
    s_add_u32 m0, s79, 2048
    s_add_u32 s81, s81, 7168
    buffer_load_dwordx4 v18, s[28:31], s81 offen lds
    s_add_u32 m0, s79, 3072
    s_add_u32 s81, s81, 7168
    buffer_load_dwordx4 v18, s[28:31], s81 offen lds
    s_add_u32 m0, s79, 4096
    s_add_u32 s81, s81, 7168
    buffer_load_dwordx4 v18, s[28:31], s81 offen lds
    s_add_u32 m0, s79, 5120
    s_add_u32 s81, s81, 7168
    buffer_load_dwordx4 v18, s[28:31], s81 offen lds
    s_add_u32 m0, s79, 6144
    s_add_u32 s81, s81, 7168
    buffer_load_dwordx4 v18, s[28:31], s81 offen lds
    s_add_u32 m0, s79, 7168
    s_add_u32 s81, s81, 7168
    buffer_load_dwordx4 v18, s[28:31], s81 offen lds
    s_add_u32 s78, s78, 1
    s_cmp_eq_u32 s78, 7
    s_cselect_b32 s78, 0, s78
    s_cmp_lg_u32 s3, 11
    s_cbranch_scc1 ld_w4
    s_lshr_b32 s6, s76, 1
    s_lshl_b32 s6, s6, 7
    s_add_u32 s6, s6, 6144
    s_add_u32 s6, s6, s89
    v_mov_b32 v5, s6
    s_mov_b64 exec, 1
    s_mov_b32 s59, 0
poll_18:
    s_sleep 2
    buffer_load_dword v4, v5, s[60:63], 0 offen sc1
    s_add_u32 s59, s59, 1
    s_cmp_gt_u32 s59, 0x100000
    s_cbranch_scc1 polle_19
    s_waitcnt vmcnt(0)
    v_cmp_lt_u32 vcc, v4, v10
    s_nop 0
    s_cbranch_vccnz poll_18
polle_19:
    s_mov_b64 exec, -1
ld_w4:
    s_waitcnt vmcnt(0)
    s_barrier
    s_barrier
    s_barrier
    s_branch all_done
compute:
    s_and_b32 s6, s4, 1
    s_lshl_b32 s6, s6, 3
    s_and_b32 s7, s5, 7
    s_add_u32 s32, s6, s7
    s_lshr_b32 s6, s4, 1
    s_lshl_b32 s6, s6, 2
    s_lshr_b32 s56, s5, 3
    s_add_u32 s33, s6, s56
    s_lshr_b32 s34, s3, 2
    s_lshl_b32 s35, s32, 1
    s_add_u32 s35, s35, s34
    s_add_u32 s35, s35, 16
    s_mov_b32 s64, 0xffff0000
    v_and_b32 v11, 31, v0
    v_lshrrev_b32 v12, 5, v0
    v_bfe_u32 v13, v0, 1, 3
    v_xor_b32 v12, v12, v13
    s_lshl_b32 s6, s58, 11
    s_lshl_b32 s7, s34, 14
    s_add_u32 s6, s6, s7
    s_add_u32 s6, s6, 114688
    v_lshlrev_b32 v19, 6, v11
    v_lshl_add_u32 v19, v12, 3, v19
    v_add_u32 v19, s6, v19
    v_xor_b32 v110, 16, v19
    v_xor_b32 v111, 32, v19
    v_xor_b32 v112, 48, v19
    v_lshlrev_b32 v12, 4, v12
    v_lshl_add_u32 v12, v11, 7, v12
    s_lshl_b32 s7, s58, 12
    v_add_u32 v6, s7, v12
    v_xor_b32 v7, 32, v6
    v_xor_b32 v8, 64, v6
    v_xor_b32 v9, 96, v6
    v_lshrrev_b32 v12, 5, v0
    v_lshlrev_b32 v12, 2, v12
    v_bfe_u32 v13, v0, 2, 2
    v_add_u32 v12, v12, v13
    v_lshlrev_b32 v108, 6, v12
    v_lshrrev_b32 v12, 1, v12
    v_bfe_u32 v13, v0, 4, 1
    v_lshlrev_b32 v13, 2, v13
    v_and_or_b32 v13, v0, 3, v13
    v_mov_b32 v18, v13
    v_xor_b32 v13, v13, v12
    v_lshl_add_u32 v108, v13, 3, v108
    v_add_u32 v108, s6, v108
    v_xor_b32 v109, 32, v108
    v_lshrrev_b32 v12, 5, v0
    v_lshlrev_b32 v17, 4, v12
    v_lshlrev_b32 v12, 3, v12
    v_bfe_u32 v13, v0, 2, 2
    v_add_u32 v12, v12, v13
    s_mul_i32 s6, s34, 7
    v_add_u32 v10, s6, v18
    v_bfe_u32 v13, v0, 3, 1
    v_lshlrev_b32 v13, 3, v13
    v_xor_b32 v10, v10, v13
    v_lshlrev_b32 v10, 3, v10
    v_lshl_add_u32 v10, v12, 7, v10
    v_add_u32 v10, 114688, v10
    v_min_u32 v18, 6, v18
    v_lshlrev_b32 v18, 3, v18
    v_lshl_add_u32 v18, v12, 6, v18
    s_and_b32 s6, s32, 1
    s_lshl_b32 s6, s6, 3
    s_add_u32 s6, s6, 122880
    v_add_u32 v18, s6, v18
    s_lshl_b32 s6, s3, 7
    s_add_u32 s6, s6, 159744
    v_add_u32 v17, s6, v17
    v_lshl_add_u32 v16, v0, 2, s6
    s_lshl_b32 s6, s3, 8
    s_add_u32 s6, s6, 161792
    v_lshl_add_u32 v14, v11, 3, s6
    v_xor_b32 v15, 1024, v14
    v_mov_b32 v20, 0
    v_mov_b32 v21, 0
    v_mov_b32 v22, 0
    v_mov_b32 v23, 0
    v_mov_b32 v24, 0
    v_mov_b32 v25, 0
    v_mov_b32 v26, 0
    v_mov_b32 v27, 0
    v_mov_b32 v28, 0
    v_mov_b32 v29, 0
    v_mov_b32 v30, 0
    v_mov_b32 v31, 0
    v_mov_b32 v32, 0
    v_mov_b32 v33, 0
    v_mov_b32 v34, 0
    v_mov_b32 v35, 0
    v_mov_b32 v36, 0
    v_mov_b32 v37, 0
    v_mov_b32 v38, 0
    v_mov_b32 v39, 0
    v_mov_b32 v40, 0
    v_mov_b32 v41, 0
    v_mov_b32 v42, 0
    v_mov_b32 v43, 0
    v_mov_b32 v44, 0
    v_mov_b32 v45, 0
    v_mov_b32 v46, 0
    v_mov_b32 v47, 0
    v_mov_b32 v52, 0
    v_mov_b32 v53, 0
    v_mov_b32 v54, 0
    v_mov_b32 v55, 0
    s_mov_b32 exec_lo, 0x20001
    s_mov_b32 exec_hi, 0x20001
    v_mov_b32 v40, 0x3f803f80
    v_mov_b32 v41, 0x3f803f80
    v_mov_b32 v42, 0x3f803f80
    v_mov_b32 v43, 0x3f803f80
    s_mov_b64 exec, -1
    s_cmp_ge_u32 s3, 3
    s_cbranch_scc1 p1_noones
    v_bfe_u32 v11, v0, 1, 1
    v_lshlrev_b32 v11, 6, v11
    v_xor_b32 v11, 112, v11
    v_lshl_add_u32 v11, v0, 7, v11
    s_lshl_b32 s6, s3, 13
    s_add_u32 s6, s6, 114688
    v_add_u32 v11, s6, v11
    v_mov_b32 v48, 0x3f803f80
    v_mov_b32 v49, 0x3f803f80
    v_mov_b32 v50, 0x3f803f80
    v_mov_b32 v51, 0x3f803f80
    ds_write_b128 v11, v[48:51]
p1_noones:
    s_waitcnt lgkmcnt(0)
    s_cmp_lt_u32 s2, 18
    s_cselect_b32 s67, s3, 0
    s_cmp_lg_u32 s67, 7
    s_cbranch_scc1 p1_noinit
    s_add_u32 s16, s54, 0xa90000
    s_addc_u32 s17, s55, 0
    s_mov_b32 s18, 0x8000
    s_mov_b32 s19, 0x20000
    s_lshl_b32 s6, s2, 10
    s_cmp_eq_u32 s2, 17
    s_cselect_b32 s6, 24576, s6
    buffer_store_dwordx4 v[20:23], v1, s[16:19], s6 offen sc1
p1_noinit:
    s_mov_b32 s12, s54
    s_mov_b32 s13, s55
    s_mov_b32 s14, 0x5e0800
    s_mov_b32 s15, 0x20000
    s_lshl_b32 s6, s33, 2
    s_add_u32 s6, s6, s58
    s_lshl_b32 s6, s6, 11
    s_add_u32 s12, s12, s6
    s_addc_u32 s13, s13, 0
    s_lshl_b32 s57, s35, 17
    s_cmp_eq_u32 s34, 1
    s_cbranch_scc1 p1_b
    s_barrier
    ds_read_b128 v[68:71], v6 offset:0
    ds_read_b64_tr_b16 v[80:81], v10 offset:0
    ds_read_b64_tr_b16 v[82:83], v10 offset:512
    ds_read_b128 v[72:75], v7 offset:0
    ds_read_b64_tr_b16 v[84:85], v10 offset:2048
    ds_read_b64_tr_b16 v[86:87], v10 offset:2560
    s_waitcnt lgkmcnt(3)
    v_mfma_f32_32x32x16_bf16 v[20:35], v[80:83], v[68:71], v[20:35]
    ds_read_b128 v[76:79], v8 offset:0
    v_lshlrev_b32 v48, 16, v68
    v_and_b32 v49, s64, v68
    v_lshlrev_b32 v50, 16, v69
    v_and_b32 v51, s64, v69
    v_mfma_f32_16x16x32_bf16 v[36:39], v[40:43], v[80:83], v[36:39]
    ds_read_b64_tr_b16 v[88:89], v10 offset:4096
    ds_read_b64_tr_b16 v[90:91], v10 offset:4608
    v_fmac_f32 v44, v48, v48
    v_fmac_f32 v45, v49, v49
    v_fmac_f32 v46, v50, v50
    v_fmac_f32 v47, v51, v51
    s_waitcnt lgkmcnt(3)
    v_mfma_f32_32x32x16_bf16 v[20:35], v[84:87], v[72:75], v[20:35]
    ds_read_b128 v[68:71], v9 offset:0
    v_lshlrev_b32 v48, 16, v72
    v_and_b32 v49, s64, v72
    v_lshlrev_b32 v50, 16, v73
    v_and_b32 v51, s64, v73
    v_mfma_f32_16x16x32_bf16 v[36:39], v[40:43], v[84:87], v[36:39]
    ds_read_b64_tr_b16 v[80:81], v10 offset:6144
    ds_read_b64_tr_b16 v[82:83], v10 offset:6656
    v_fmac_f32 v44, v48, v48
    v_fmac_f32 v45, v49, v49
    v_fmac_f32 v46, v50, v50
    v_fmac_f32 v47, v51, v51
    s_waitcnt lgkmcnt(3)
    v_mfma_f32_32x32x16_bf16 v[20:35], v[88:91], v[76:79], v[20:35]
    v_lshlrev_b32 v48, 16, v76
    v_and_b32 v49, s64, v76
    v_lshlrev_b32 v50, 16, v77
    v_and_b32 v51, s64, v77
    v_mfma_f32_16x16x32_bf16 v[36:39], v[40:43], v[88:91], v[36:39]
    v_fmac_f32 v44, v48, v48
    v_fmac_f32 v45, v49, v49
    v_fmac_f32 v46, v50, v50
    v_fmac_f32 v47, v51, v51
    s_waitcnt lgkmcnt(0)
    s_barrier
    ds_read_b128 v[72:75], v6 offset:16384
    ds_read_b64_tr_b16 v[84:85], v10 offset:8192
    ds_read_b64_tr_b16 v[86:87], v10 offset:8704
    s_waitcnt lgkmcnt(3)
    v_mfma_f32_32x32x16_bf16 v[20:35], v[80:83], v[68:71], v[20:35]
    ds_read_b128 v[76:79], v7 offset:16384
    v_lshlrev_b32 v48, 16, v68
    v_and_b32 v49, s64, v68
    v_lshlrev_b32 v50, 16, v69
    v_and_b32 v51, s64, v69
    v_mfma_f32_16x16x32_bf16 v[36:39], v[40:43], v[80:83], v[36:39]
    ds_read_b64_tr_b16 v[88:89], v10 offset:10240
    ds_read_b64_tr_b16 v[90:91], v10 offset:10752
    v_fmac_f32 v44, v48, v48
    v_fmac_f32 v45, v49, v49
    v_fmac_f32 v46, v50, v50
    v_fmac_f32 v47, v51, v51
    s_waitcnt lgkmcnt(3)
    v_mfma_f32_32x32x16_bf16 v[20:35], v[84:87], v[72:75], v[20:35]
    ds_read_b128 v[68:71], v8 offset:16384
    v_lshlrev_b32 v48, 16, v72
    v_and_b32 v49, s64, v72
    v_lshlrev_b32 v50, 16, v73
    v_and_b32 v51, s64, v73
    v_mfma_f32_16x16x32_bf16 v[36:39], v[40:43], v[84:87], v[36:39]
    ds_read_b64_tr_b16 v[80:81], v10 offset:12288
    ds_read_b64_tr_b16 v[82:83], v10 offset:12800
    v_fmac_f32 v44, v48, v48
    v_fmac_f32 v45, v49, v49
    v_fmac_f32 v46, v50, v50
    v_fmac_f32 v47, v51, v51
    s_waitcnt lgkmcnt(3)
    v_mfma_f32_32x32x16_bf16 v[20:35], v[88:91], v[76:79], v[20:35]
    ds_read_b128 v[72:75], v9 offset:16384
    v_lshlrev_b32 v48, 16, v76
    v_and_b32 v49, s64, v76
    v_lshlrev_b32 v50, 16, v77
    v_and_b32 v51, s64, v77
    v_mfma_f32_16x16x32_bf16 v[36:39], v[40:43], v[88:91], v[36:39]
    ds_read_b64_tr_b16 v[84:85], v10 offset:14336
    ds_read_b64_tr_b16 v[86:87], v10 offset:14848
    v_fmac_f32 v44, v48, v48
    v_fmac_f32 v45, v49, v49
    v_fmac_f32 v46, v50, v50
    v_fmac_f32 v47, v51, v51
    s_waitcnt lgkmcnt(3)
    v_mfma_f32_32x32x16_bf16 v[20:35], v[80:83], v[68:71], v[20:35]
    v_lshlrev_b32 v48, 16, v68
    v_and_b32 v49, s64, v68
    v_lshlrev_b32 v50, 16, v69
    v_and_b32 v51, s64, v69
    v_mfma_f32_16x16x32_bf16 v[36:39], v[40:43], v[80:83], v[36:39]
    v_fmac_f32 v44, v48, v48
    v_fmac_f32 v45, v49, v49
    v_fmac_f32 v46, v50, v50
    v_fmac_f32 v47, v51, v51
    s_waitcnt lgkmcnt(0)
    s_barrier
    ds_read_b128 v[76:79], v6 offset:32768
    ds_read_b64_tr_b16 v[88:89], v10 offset:16384
    ds_read_b64_tr_b16 v[90:91], v10 offset:16896
    s_waitcnt lgkmcnt(3)
    v_mfma_f32_32x32x16_bf16 v[20:35], v[84:87], v[72:75], v[20:35]
    ds_read_b128 v[68:71], v7 offset:32768
    v_lshlrev_b32 v48, 16, v72
    v_and_b32 v49, s64, v72
    v_lshlrev_b32 v50, 16, v73
    v_and_b32 v51, s64, v73
    v_mfma_f32_16x16x32_bf16 v[36:39], v[40:43], v[84:87], v[36:39]
    ds_read_b64_tr_b16 v[80:81], v10 offset:18432
    ds_read_b64_tr_b16 v[82:83], v10 offset:18944
    v_fmac_f32 v44, v48, v48
    v_fmac_f32 v45, v49, v49
    v_fmac_f32 v46, v50, v50
    v_fmac_f32 v47, v51, v51
    s_waitcnt lgkmcnt(3)
    v_mfma_f32_32x32x16_bf16 v[20:35], v[88:91], v[76:79], v[20:35]
    ds_read_b128 v[72:75], v8 offset:32768
    v_lshlrev_b32 v48, 16, v76
    v_and_b32 v49, s64, v76
    v_lshlrev_b32 v50, 16, v77
    v_and_b32 v51, s64, v77
    v_mfma_f32_16x16x32_bf16 v[36:39], v[40:43], v[88:91], v[36:39]
    ds_read_b64_tr_b16 v[84:85], v10 offset:20480
    ds_read_b64_tr_b16 v[86:87], v10 offset:20992
    v_fmac_f32 v44, v48, v48
    v_fmac_f32 v45, v49, v49
    v_fmac_f32 v46, v50, v50
    v_fmac_f32 v47, v51, v51
    s_waitcnt lgkmcnt(3)
    v_mfma_f32_32x32x16_bf16 v[20:35], v[80:83], v[68:71], v[20:35]
    ds_read_b128 v[76:79], v9 offset:32768
    v_lshlrev_b32 v48, 16, v68
    v_and_b32 v49, s64, v68
    v_lshlrev_b32 v50, 16, v69
    v_and_b32 v51, s64, v69
    v_mfma_f32_16x16x32_bf16 v[36:39], v[40:43], v[80:83], v[36:39]
    ds_read_b64_tr_b16 v[88:89], v10 offset:22528
    ds_read_b64_tr_b16 v[90:91], v10 offset:23040
    v_fmac_f32 v44, v48, v48
    v_fmac_f32 v45, v49, v49
    v_fmac_f32 v46, v50, v50
    v_fmac_f32 v47, v51, v51
    s_waitcnt lgkmcnt(3)
    v_mfma_f32_32x32x16_bf16 v[20:35], v[84:87], v[72:75], v[20:35]
    v_lshlrev_b32 v48, 16, v72
    v_and_b32 v49, s64, v72
    v_lshlrev_b32 v50, 16, v73
    v_and_b32 v51, s64, v73
    v_mfma_f32_16x16x32_bf16 v[36:39], v[40:43], v[84:87], v[36:39]
    v_fmac_f32 v44, v48, v48
    v_fmac_f32 v45, v49, v49
    v_fmac_f32 v46, v50, v50
    v_fmac_f32 v47, v51, v51
    s_waitcnt lgkmcnt(0)
    s_barrier
    ds_read_b128 v[68:71], v6 offset:49152
    ds_read_b64_tr_b16 v[80:81], v10 offset:0
    ds_read_b64_tr_b16 v[82:83], v10 offset:512
    s_waitcnt lgkmcnt(3)
    v_mfma_f32_32x32x16_bf16 v[20:35], v[88:91], v[76:79], v[20:35]
    ds_read_b128 v[72:75], v7 offset:49152
    v_lshlrev_b32 v48, 16, v76
    v_and_b32 v49, s64, v76
    v_lshlrev_b32 v50, 16, v77
    v_and_b32 v51, s64, v77
    v_mfma_f32_16x16x32_bf16 v[36:39], v[40:43], v[88:91], v[36:39]
    ds_read_b64_tr_b16 v[84:85], v10 offset:2048
    ds_read_b64_tr_b16 v[86:87], v10 offset:2560
    v_fmac_f32 v44, v48, v48
    v_fmac_f32 v45, v49, v49
    v_fmac_f32 v46, v50, v50
    v_fmac_f32 v47, v51, v51
    s_waitcnt lgkmcnt(3)
    v_mfma_f32_32x32x16_bf16 v[20:35], v[80:83], v[68:71], v[20:35]
    ds_read_b128 v[76:79], v8 offset:49152
    v_lshlrev_b32 v48, 16, v68
    v_and_b32 v49, s64, v68
    v_lshlrev_b32 v50, 16, v69
    v_and_b32 v51, s64, v69
    v_mfma_f32_16x16x32_bf16 v[36:39], v[40:43], v[80:83], v[36:39]
    ds_read_b64_tr_b16 v[88:89], v10 offset:4096
    ds_read_b64_tr_b16 v[90:91], v10 offset:4608
    v_fmac_f32 v44, v48, v48
    v_fmac_f32 v45, v49, v49
    v_fmac_f32 v46, v50, v50
    v_fmac_f32 v47, v51, v51
    s_waitcnt lgkmcnt(3)
    v_mfma_f32_32x32x16_bf16 v[20:35], v[84:87], v[72:75], v[20:35]
    ds_read_b128 v[68:71], v9 offset:49152
    v_lshlrev_b32 v48, 16, v72
    v_and_b32 v49, s64, v72
    v_lshlrev_b32 v50, 16, v73
    v_and_b32 v51, s64, v73
    v_mfma_f32_16x16x32_bf16 v[36:39], v[40:43], v[84:87], v[36:39]
    ds_read_b64_tr_b16 v[80:81], v10 offset:6144
    ds_read_b64_tr_b16 v[82:83], v10 offset:6656
    v_fmac_f32 v44, v48, v48
    v_fmac_f32 v45, v49, v49
    v_fmac_f32 v46, v50, v50
    v_fmac_f32 v47, v51, v51
    s_waitcnt lgkmcnt(3)
    v_mfma_f32_32x32x16_bf16 v[20:35], v[88:91], v[76:79], v[20:35]
    v_lshlrev_b32 v48, 16, v76
    v_and_b32 v49, s64, v76
    v_lshlrev_b32 v50, 16, v77
    v_and_b32 v51, s64, v77
    v_mfma_f32_16x16x32_bf16 v[36:39], v[40:43], v[88:91], v[36:39]
    v_fmac_f32 v44, v48, v48
    v_fmac_f32 v45, v49, v49
    v_fmac_f32 v46, v50, v50
    v_fmac_f32 v47, v51, v51
    s_waitcnt lgkmcnt(0)
    s_barrier
    v_add_u32 v6, 0x10000, v6
    v_add_u32 v7, 0x10000, v7
    v_add_u32 v8, 0x10000, v8
    v_add_u32 v9, 0x10000, v9
    ds_read_b128 v[72:75], v6 offset:0
    ds_read_b64_tr_b16 v[84:85], v10 offset:8192
    ds_read_b64_tr_b16 v[86:87], v10 offset:8704
    s_waitcnt lgkmcnt(3)
    v_mfma_f32_32x32x16_bf16 v[20:35], v[80:83], v[68:71], v[20:35]
    ds_read_b128 v[76:79], v7 offset:0
    v_lshlrev_b32 v48, 16, v68
    v_and_b32 v49, s64, v68
    v_lshlrev_b32 v50, 16, v69
    v_and_b32 v51, s64, v69
    v_mfma_f32_16x16x32_bf16 v[36:39], v[40:43], v[80:83], v[36:39]
    ds_read_b64_tr_b16 v[88:89], v10 offset:10240
    ds_read_b64_tr_b16 v[90:91], v10 offset:10752
    v_fmac_f32 v44, v48, v48
    v_fmac_f32 v45, v49, v49
    v_fmac_f32 v46, v50, v50
    v_fmac_f32 v47, v51, v51
    s_waitcnt lgkmcnt(3)
    v_mfma_f32_32x32x16_bf16 v[20:35], v[84:87], v[72:75], v[20:35]
    ds_read_b128 v[68:71], v8 offset:0
    v_lshlrev_b32 v48, 16, v72
    v_and_b32 v49, s64, v72
    v_lshlrev_b32 v50, 16, v73
    v_and_b32 v51, s64, v73
    v_mfma_f32_16x16x32_bf16 v[36:39], v[40:43], v[84:87], v[36:39]
    ds_read_b64_tr_b16 v[80:81], v10 offset:12288
    ds_read_b64_tr_b16 v[82:83], v10 offset:12800
    v_fmac_f32 v44, v48, v48
    v_fmac_f32 v45, v49, v49
    v_fmac_f32 v46, v50, v50
    v_fmac_f32 v47, v51, v51
    s_waitcnt lgkmcnt(3)
    v_mfma_f32_32x32x16_bf16 v[20:35], v[88:91], v[76:79], v[20:35]
    ds_read_b128 v[72:75], v9 offset:0
    v_lshlrev_b32 v48, 16, v76
    v_and_b32 v49, s64, v76
    v_lshlrev_b32 v50, 16, v77
    v_and_b32 v51, s64, v77
    v_mfma_f32_16x16x32_bf16 v[36:39], v[40:43], v[88:91], v[36:39]
    ds_read_b64_tr_b16 v[84:85], v10 offset:14336
    ds_read_b64_tr_b16 v[86:87], v10 offset:14848
    v_fmac_f32 v44, v48, v48
    v_fmac_f32 v45, v49, v49
    v_fmac_f32 v46, v50, v50
    v_fmac_f32 v47, v51, v51
    s_waitcnt lgkmcnt(3)
    v_mfma_f32_32x32x16_bf16 v[20:35], v[80:83], v[68:71], v[20:35]
    v_lshlrev_b32 v48, 16, v68
    v_and_b32 v49, s64, v68
    v_lshlrev_b32 v50, 16, v69
    v_and_b32 v51, s64, v69
    v_mfma_f32_16x16x32_bf16 v[36:39], v[40:43], v[80:83], v[36:39]
    v_fmac_f32 v44, v48, v48
    v_fmac_f32 v45, v49, v49
    v_fmac_f32 v46, v50, v50
    v_fmac_f32 v47, v51, v51
    s_waitcnt lgkmcnt(0)
    s_barrier
    ds_read_b128 v[76:79], v6 offset:16384
    ds_read_b64_tr_b16 v[88:89], v10 offset:16384
    ds_read_b64_tr_b16 v[90:91], v10 offset:16896
    s_waitcnt lgkmcnt(3)
    v_mfma_f32_32x32x16_bf16 v[20:35], v[84:87], v[72:75], v[20:35]
    ds_read_b128 v[68:71], v7 offset:16384
    v_lshlrev_b32 v48, 16, v72
    v_and_b32 v49, s64, v72
    v_lshlrev_b32 v50, 16, v73
    v_and_b32 v51, s64, v73
    v_mfma_f32_16x16x32_bf16 v[36:39], v[40:43], v[84:87], v[36:39]
    ds_read_b64_tr_b16 v[80:81], v10 offset:18432
    ds_read_b64_tr_b16 v[82:83], v10 offset:18944
    v_fmac_f32 v44, v48, v48
    v_fmac_f32 v45, v49, v49
    v_fmac_f32 v46, v50, v50
    v_fmac_f32 v47, v51, v51
    s_waitcnt lgkmcnt(3)
    v_mfma_f32_32x32x16_bf16 v[20:35], v[88:91], v[76:79], v[20:35]
    ds_read_b128 v[72:75], v8 offset:16384
    v_lshlrev_b32 v48, 16, v76
    v_and_b32 v49, s64, v76
    v_lshlrev_b32 v50, 16, v77
    v_and_b32 v51, s64, v77
    v_mfma_f32_16x16x32_bf16 v[36:39], v[40:43], v[88:91], v[36:39]
    ds_read_b64_tr_b16 v[84:85], v10 offset:20480
    ds_read_b64_tr_b16 v[86:87], v10 offset:20992
    v_fmac_f32 v44, v48, v48
    v_fmac_f32 v45, v49, v49
    v_fmac_f32 v46, v50, v50
    v_fmac_f32 v47, v51, v51
    s_waitcnt lgkmcnt(3)
    v_mfma_f32_32x32x16_bf16 v[20:35], v[80:83], v[68:71], v[20:35]
    ds_read_b128 v[76:79], v9 offset:16384
    v_lshlrev_b32 v48, 16, v68
    v_and_b32 v49, s64, v68
    v_lshlrev_b32 v50, 16, v69
    v_and_b32 v51, s64, v69
    v_mfma_f32_16x16x32_bf16 v[36:39], v[40:43], v[80:83], v[36:39]
    ds_read_b64_tr_b16 v[88:89], v10 offset:22528
    ds_read_b64_tr_b16 v[90:91], v10 offset:23040
    v_fmac_f32 v44, v48, v48
    v_fmac_f32 v45, v49, v49
    v_fmac_f32 v46, v50, v50
    v_fmac_f32 v47, v51, v51
    s_waitcnt lgkmcnt(3)
    v_mfma_f32_32x32x16_bf16 v[20:35], v[84:87], v[72:75], v[20:35]
    v_lshlrev_b32 v48, 16, v72
    v_and_b32 v49, s64, v72
    v_lshlrev_b32 v50, 16, v73
    v_and_b32 v51, s64, v73
    v_mfma_f32_16x16x32_bf16 v[36:39], v[40:43], v[84:87], v[36:39]
    v_fmac_f32 v44, v48, v48
    v_fmac_f32 v45, v49, v49
    v_fmac_f32 v46, v50, v50
    v_fmac_f32 v47, v51, v51
    s_waitcnt lgkmcnt(0)
    s_barrier
    ds_read_b128 v[68:71], v6 offset:32768
    ds_read_b64_tr_b16 v[80:81], v10 offset:0
    ds_read_b64_tr_b16 v[82:83], v10 offset:512
    s_waitcnt lgkmcnt(3)
    v_mfma_f32_32x32x16_bf16 v[20:35], v[88:91], v[76:79], v[20:35]
    ds_read_b128 v[72:75], v7 offset:32768
    v_lshlrev_b32 v48, 16, v76
    v_and_b32 v49, s64, v76
    v_lshlrev_b32 v50, 16, v77
    v_and_b32 v51, s64, v77
    v_mfma_f32_16x16x32_bf16 v[36:39], v[40:43], v[88:91], v[36:39]
    ds_read_b64_tr_b16 v[84:85], v10 offset:2048
    ds_read_b64_tr_b16 v[86:87], v10 offset:2560
    v_fmac_f32 v44, v48, v48
    v_fmac_f32 v45, v49, v49
    v_fmac_f32 v46, v50, v50
    v_fmac_f32 v47, v51, v51
    s_waitcnt lgkmcnt(3)
    v_mfma_f32_32x32x16_bf16 v[20:35], v[80:83], v[68:71], v[20:35]
    ds_read_b128 v[76:79], v8 offset:32768
    v_lshlrev_b32 v48, 16, v68
    v_and_b32 v49, s64, v68
    v_lshlrev_b32 v50, 16, v69
    v_and_b32 v51, s64, v69
    v_mfma_f32_16x16x32_bf16 v[36:39], v[40:43], v[80:83], v[36:39]
    ds_read_b64_tr_b16 v[88:89], v10 offset:4096
    ds_read_b64_tr_b16 v[90:91], v10 offset:4608
    v_fmac_f32 v44, v48, v48
    v_fmac_f32 v45, v49, v49
    v_fmac_f32 v46, v50, v50
    v_fmac_f32 v47, v51, v51
    s_waitcnt lgkmcnt(3)
    v_mfma_f32_32x32x16_bf16 v[20:35], v[84:87], v[72:75], v[20:35]
    ds_read_b128 v[68:71], v9 offset:32768
    v_lshlrev_b32 v48, 16, v72
    v_and_b32 v49, s64, v72
    v_lshlrev_b32 v50, 16, v73
    v_and_b32 v51, s64, v73
    v_mfma_f32_16x16x32_bf16 v[36:39], v[40:43], v[84:87], v[36:39]
    ds_read_b64_tr_b16 v[80:81], v10 offset:6144
    ds_read_b64_tr_b16 v[82:83], v10 offset:6656
    v_fmac_f32 v44, v48, v48
    v_fmac_f32 v45, v49, v49
    v_fmac_f32 v46, v50, v50
    v_fmac_f32 v47, v51, v51
    s_waitcnt lgkmcnt(3)
    v_mfma_f32_32x32x16_bf16 v[20:35], v[88:91], v[76:79], v[20:35]
    v_lshlrev_b32 v48, 16, v76
    v_and_b32 v49, s64, v76
    v_lshlrev_b32 v50, 16, v77
    v_and_b32 v51, s64, v77
    v_mfma_f32_16x16x32_bf16 v[36:39], v[40:43], v[88:91], v[36:39]
    v_fmac_f32 v44, v48, v48
    v_fmac_f32 v45, v49, v49
    v_fmac_f32 v46, v50, v50
    v_fmac_f32 v47, v51, v51
    s_waitcnt lgkmcnt(0)
    v_mfma_f32_32x32x16_bf16 v[20:35], v[80:83], v[68:71], v[20:35]
    v_lshlrev_b32 v48, 16, v68
    v_and_b32 v49, s64, v68
    v_lshlrev_b32 v50, 16, v69
    v_and_b32 v51, s64, v69
    v_mfma_f32_16x16x32_bf16 v[36:39], v[40:43], v[80:83], v[36:39]
    v_fmac_f32 v44, v48, v48
    v_fmac_f32 v45, v49, v49
    v_fmac_f32 v46, v50, v50
    v_fmac_f32 v47, v51, v51
    s_branch p1_j
p1_b:
    s_barrier
    ds_read_b128 v[68:71], v6 offset:0
    ds_read_b64_tr_b16 v[80:81], v10 offset:0
    ds_read_b64_tr_b16 v[82:83], v10 offset:512
    ds_read_b128 v[72:75], v7 offset:0
    ds_read_b64_tr_b16 v[84:85], v10 offset:2048
    ds_read_b64_tr_b16 v[86:87], v10 offset:2560
    s_waitcnt lgkmcnt(3)
    v_mfma_f32_32x32x16_bf16 v[20:35], v[80:83], v[68:71], v[20:35]
    ds_read_b128 v[76:79], v8 offset:0
    v_lshlrev_b32 v48, 16, v70
    v_and_b32 v49, s64, v70
    v_lshlrev_b32 v50, 16, v71
    v_and_b32 v51, s64, v71
    v_mfma_f32_16x16x32_bf16 v[36:39], v[40:43], v[80:83], v[36:39]
    ds_read_b64_tr_b16 v[88:89], v10 offset:4096
    ds_read_b64_tr_b16 v[90:91], v10 offset:4608
    v_fmac_f32 v44, v48, v48
    v_fmac_f32 v45, v49, v49
    v_fmac_f32 v46, v50, v50
    v_fmac_f32 v47, v51, v51
    s_waitcnt lgkmcnt(3)
    v_mfma_f32_32x32x16_bf16 v[20:35], v[84:87], v[72:75], v[20:35]
    ds_read_b128 v[68:71], v9 offset:0
    v_lshlrev_b32 v48, 16, v74
    v_and_b32 v49, s64, v74
    v_lshlrev_b32 v50, 16, v75
    v_and_b32 v51, s64, v75
    v_mfma_f32_16x16x32_bf16 v[36:39], v[40:43], v[84:87], v[36:39]
    ds_read_b64_tr_b16 v[80:81], v10 offset:6144
    ds_read_b64_tr_b16 v[82:83], v10 offset:6656
    v_fmac_f32 v44, v48, v48
    v_fmac_f32 v45, v49, v49
    v_fmac_f32 v46, v50, v50
    v_fmac_f32 v47, v51, v51
    s_waitcnt lgkmcnt(3)
    v_mfma_f32_32x32x16_bf16 v[20:35], v[88:91], v[76:79], v[20:35]
    v_lshlrev_b32 v48, 16, v78
    v_and_b32 v49, s64, v78
    v_lshlrev_b32 v50, 16, v79
    v_and_b32 v51, s64, v79
    v_mfma_f32_16x16x32_bf16 v[36:39], v[40:43], v[88:91], v[36:39]
    v_fmac_f32 v44, v48, v48
    v_fmac_f32 v45, v49, v49
    v_fmac_f32 v46, v50, v50
    v_fmac_f32 v47, v51, v51
    s_waitcnt lgkmcnt(0)
    s_barrier
    ds_read_b128 v[72:75], v6 offset:16384
    ds_read_b64_tr_b16 v[84:85], v10 offset:8192
    ds_read_b64_tr_b16 v[86:87], v10 offset:8704
    s_waitcnt lgkmcnt(3)
    v_mfma_f32_32x32x16_bf16 v[20:35], v[80:83], v[68:71], v[20:35]
    ds_read_b128 v[76:79], v7 offset:16384
    v_lshlrev_b32 v48, 16, v70
    v_and_b32 v49, s64, v70
    v_lshlrev_b32 v50, 16, v71
    v_and_b32 v51, s64, v71
    v_mfma_f32_16x16x32_bf16 v[36:39], v[40:43], v[80:83], v[36:39]
    ds_read_b64_tr_b16 v[88:89], v10 offset:10240
    ds_read_b64_tr_b16 v[90:91], v10 offset:10752
    v_fmac_f32 v44, v48, v48
    v_fmac_f32 v45, v49, v49
    v_fmac_f32 v46, v50, v50
    v_fmac_f32 v47, v51, v51
    s_waitcnt lgkmcnt(3)
    v_mfma_f32_32x32x16_bf16 v[20:35], v[84:87], v[72:75], v[20:35]
    ds_read_b128 v[68:71], v8 offset:16384
    v_lshlrev_b32 v48, 16, v74
    v_and_b32 v49, s64, v74
    v_lshlrev_b32 v50, 16, v75
    v_and_b32 v51, s64, v75
    v_mfma_f32_16x16x32_bf16 v[36:39], v[40:43], v[84:87], v[36:39]
    ds_read_b64_tr_b16 v[80:81], v10 offset:12288
    ds_read_b64_tr_b16 v[82:83], v10 offset:12800
    v_fmac_f32 v44, v48, v48
    v_fmac_f32 v45, v49, v49
    v_fmac_f32 v46, v50, v50
    v_fmac_f32 v47, v51, v51
    s_waitcnt lgkmcnt(3)
    v_mfma_f32_32x32x16_bf16 v[20:35], v[88:91], v[76:79], v[20:35]
    ds_read_b128 v[72:75], v9 offset:16384
    v_lshlrev_b32 v48, 16, v78
    v_and_b32 v49, s64, v78
    v_lshlrev_b32 v50, 16, v79
    v_and_b32 v51, s64, v79
    v_mfma_f32_16x16x32_bf16 v[36:39], v[40:43], v[88:91], v[36:39]
    ds_read_b64_tr_b16 v[84:85], v10 offset:14336
    ds_read_b64_tr_b16 v[86:87], v10 offset:14848
    v_fmac_f32 v44, v48, v48
    v_fmac_f32 v45, v49, v49
    v_fmac_f32 v46, v50, v50
    v_fmac_f32 v47, v51, v51
    s_cmp_lg_u32 s67, 7
    s_cbranch_scc1 p1_nordy
    s_mov_b32 s20, s52
    s_mov_b32 s21, s53
    s_mov_b32 s22, 0x100
    s_mov_b32 s23, 0x20000
    v_mov_b32 v11, 0
    v_mov_b32 v12, 1
    s_mov_b64 exec, 1
    s_waitcnt vmcnt(0)
    buffer_atomic_add v12, v11, s[20:23], 0 offen sc1
    s_mov_b64 exec, -1
p1_nordy:
    s_waitcnt lgkmcnt(3)
    v_mfma_f32_32x32x16_bf16 v[20:35], v[80:83], v[68:71], v[20:35]
    v_lshlrev_b32 v48, 16, v70
    v_and_b32 v49, s64, v70
    v_lshlrev_b32 v50, 16, v71
    v_and_b32 v51, s64, v71
    v_mfma_f32_16x16x32_bf16 v[36:39], v[40:43], v[80:83], v[36:39]
    v_fmac_f32 v44, v48, v48
    v_fmac_f32 v45, v49, v49
    v_fmac_f32 v46, v50, v50
    v_fmac_f32 v47, v51, v51
    s_waitcnt lgkmcnt(0)
    s_barrier
    ds_read_b128 v[76:79], v6 offset:32768
    ds_read_b64_tr_b16 v[88:89], v10 offset:16384
    ds_read_b64_tr_b16 v[90:91], v10 offset:16896
    s_waitcnt lgkmcnt(3)
    v_mfma_f32_32x32x16_bf16 v[20:35], v[84:87], v[72:75], v[20:35]
    ds_read_b128 v[68:71], v7 offset:32768
    v_lshlrev_b32 v48, 16, v74
    v_and_b32 v49, s64, v74
    v_lshlrev_b32 v50, 16, v75
    v_and_b32 v51, s64, v75
    v_mfma_f32_16x16x32_bf16 v[36:39], v[40:43], v[84:87], v[36:39]
    ds_read_b64_tr_b16 v[80:81], v10 offset:18432
    ds_read_b64_tr_b16 v[82:83], v10 offset:18944
    v_fmac_f32 v44, v48, v48
    v_fmac_f32 v45, v49, v49
    v_fmac_f32 v46, v50, v50
    v_fmac_f32 v47, v51, v51
    s_waitcnt lgkmcnt(3)
    v_mfma_f32_32x32x16_bf16 v[20:35], v[88:91], v[76:79], v[20:35]
    ds_read_b128 v[72:75], v8 offset:32768
    v_lshlrev_b32 v48, 16, v78
    v_and_b32 v49, s64, v78
    v_lshlrev_b32 v50, 16, v79
    v_and_b32 v51, s64, v79
    v_mfma_f32_16x16x32_bf16 v[36:39], v[40:43], v[88:91], v[36:39]
    ds_read_b64_tr_b16 v[84:85], v10 offset:20480
    ds_read_b64_tr_b16 v[86:87], v10 offset:20992
    v_fmac_f32 v44, v48, v48
    v_fmac_f32 v45, v49, v49
    v_fmac_f32 v46, v50, v50
    v_fmac_f32 v47, v51, v51
    s_waitcnt lgkmcnt(3)
    v_mfma_f32_32x32x16_bf16 v[20:35], v[80:83], v[68:71], v[20:35]
    ds_read_b128 v[76:79], v9 offset:32768
    v_lshlrev_b32 v48, 16, v70
    v_and_b32 v49, s64, v70
    v_lshlrev_b32 v50, 16, v71
    v_and_b32 v51, s64, v71
    v_mfma_f32_16x16x32_bf16 v[36:39], v[40:43], v[80:83], v[36:39]
    ds_read_b64_tr_b16 v[88:89], v10 offset:22528
    ds_read_b64_tr_b16 v[90:91], v10 offset:23040
    v_fmac_f32 v44, v48, v48
    v_fmac_f32 v45, v49, v49
    v_fmac_f32 v46, v50, v50
    v_fmac_f32 v47, v51, v51
    s_waitcnt lgkmcnt(3)
    v_mfma_f32_32x32x16_bf16 v[20:35], v[84:87], v[72:75], v[20:35]
    v_lshlrev_b32 v48, 16, v74
    v_and_b32 v49, s64, v74
    v_lshlrev_b32 v50, 16, v75
    v_and_b32 v51, s64, v75
    v_mfma_f32_16x16x32_bf16 v[36:39], v[40:43], v[84:87], v[36:39]
    v_fmac_f32 v44, v48, v48
    v_fmac_f32 v45, v49, v49
    v_fmac_f32 v46, v50, v50
    v_fmac_f32 v47, v51, v51
    s_waitcnt lgkmcnt(0)
    s_barrier
    ds_read_b128 v[68:71], v6 offset:49152
    ds_read_b64_tr_b16 v[80:81], v10 offset:0
    ds_read_b64_tr_b16 v[82:83], v10 offset:512
    s_waitcnt lgkmcnt(3)
    v_mfma_f32_32x32x16_bf16 v[20:35], v[88:91], v[76:79], v[20:35]
    ds_read_b128 v[72:75], v7 offset:49152
    v_lshlrev_b32 v48, 16, v78
    v_and_b32 v49, s64, v78
    v_lshlrev_b32 v50, 16, v79
    v_and_b32 v51, s64, v79
    v_mfma_f32_16x16x32_bf16 v[36:39], v[40:43], v[88:91], v[36:39]
    ds_read_b64_tr_b16 v[84:85], v10 offset:2048
    ds_read_b64_tr_b16 v[86:87], v10 offset:2560
    v_fmac_f32 v44, v48, v48
    v_fmac_f32 v45, v49, v49
    v_fmac_f32 v46, v50, v50
    v_fmac_f32 v47, v51, v51
    s_waitcnt lgkmcnt(3)
    v_mfma_f32_32x32x16_bf16 v[20:35], v[80:83], v[68:71], v[20:35]
    ds_read_b128 v[76:79], v8 offset:49152
    v_lshlrev_b32 v48, 16, v70
    v_and_b32 v49, s64, v70
    v_lshlrev_b32 v50, 16, v71
    v_and_b32 v51, s64, v71
    v_mfma_f32_16x16x32_bf16 v[36:39], v[40:43], v[80:83], v[36:39]
    ds_read_b64_tr_b16 v[88:89], v10 offset:4096
    ds_read_b64_tr_b16 v[90:91], v10 offset:4608
    v_fmac_f32 v44, v48, v48
    v_fmac_f32 v45, v49, v49
    v_fmac_f32 v46, v50, v50
    v_fmac_f32 v47, v51, v51
    s_waitcnt lgkmcnt(3)
    v_mfma_f32_32x32x16_bf16 v[20:35], v[84:87], v[72:75], v[20:35]
    ds_read_b128 v[68:71], v9 offset:49152
    v_lshlrev_b32 v48, 16, v74
    v_and_b32 v49, s64, v74
    v_lshlrev_b32 v50, 16, v75
    v_and_b32 v51, s64, v75
    v_mfma_f32_16x16x32_bf16 v[36:39], v[40:43], v[84:87], v[36:39]
    ds_read_b64_tr_b16 v[80:81], v10 offset:6144
    ds_read_b64_tr_b16 v[82:83], v10 offset:6656
    v_fmac_f32 v44, v48, v48
    v_fmac_f32 v45, v49, v49
    v_fmac_f32 v46, v50, v50
    v_fmac_f32 v47, v51, v51
    s_waitcnt lgkmcnt(3)
    v_mfma_f32_32x32x16_bf16 v[20:35], v[88:91], v[76:79], v[20:35]
    v_lshlrev_b32 v48, 16, v78
    v_and_b32 v49, s64, v78
    v_lshlrev_b32 v50, 16, v79
    v_and_b32 v51, s64, v79
    v_mfma_f32_16x16x32_bf16 v[36:39], v[40:43], v[88:91], v[36:39]
    v_fmac_f32 v44, v48, v48
    v_fmac_f32 v45, v49, v49
    v_fmac_f32 v46, v50, v50
    v_fmac_f32 v47, v51, v51
    s_waitcnt lgkmcnt(0)
    s_barrier
    v_add_u32 v6, 0x10000, v6
    v_add_u32 v7, 0x10000, v7
    v_add_u32 v8, 0x10000, v8
    v_add_u32 v9, 0x10000, v9
    ds_read_b128 v[72:75], v6 offset:0
    ds_read_b64_tr_b16 v[84:85], v10 offset:8192
    ds_read_b64_tr_b16 v[86:87], v10 offset:8704
    s_waitcnt lgkmcnt(3)
    v_mfma_f32_32x32x16_bf16 v[20:35], v[80:83], v[68:71], v[20:35]
    ds_read_b128 v[76:79], v7 offset:0
    v_lshlrev_b32 v48, 16, v70
    v_and_b32 v49, s64, v70
    v_lshlrev_b32 v50, 16, v71
    v_and_b32 v51, s64, v71
    v_mfma_f32_16x16x32_bf16 v[36:39], v[40:43], v[80:83], v[36:39]
    ds_read_b64_tr_b16 v[88:89], v10 offset:10240
    ds_read_b64_tr_b16 v[90:91], v10 offset:10752
    v_fmac_f32 v44, v48, v48
    v_fmac_f32 v45, v49, v49
    v_fmac_f32 v46, v50, v50
    v_fmac_f32 v47, v51, v51
    s_waitcnt lgkmcnt(3)
    v_mfma_f32_32x32x16_bf16 v[20:35], v[84:87], v[72:75], v[20:35]
    ds_read_b128 v[68:71], v8 offset:0
    v_lshlrev_b32 v48, 16, v74
    v_and_b32 v49, s64, v74
    v_lshlrev_b32 v50, 16, v75
    v_and_b32 v51, s64, v75
    v_mfma_f32_16x16x32_bf16 v[36:39], v[40:43], v[84:87], v[36:39]
    ds_read_b64_tr_b16 v[80:81], v10 offset:12288
    ds_read_b64_tr_b16 v[82:83], v10 offset:12800
    v_fmac_f32 v44, v48, v48
    v_fmac_f32 v45, v49, v49
    v_fmac_f32 v46, v50, v50
    v_fmac_f32 v47, v51, v51
    s_waitcnt lgkmcnt(3)
    v_mfma_f32_32x32x16_bf16 v[20:35], v[88:91], v[76:79], v[20:35]
    ds_read_b128 v[72:75], v9 offset:0
    v_lshlrev_b32 v48, 16, v78
    v_and_b32 v49, s64, v78
    v_lshlrev_b32 v50, 16, v79
    v_and_b32 v51, s64, v79
    v_mfma_f32_16x16x32_bf16 v[36:39], v[40:43], v[88:91], v[36:39]
    ds_read_b64_tr_b16 v[84:85], v10 offset:14336
    ds_read_b64_tr_b16 v[86:87], v10 offset:14848
    v_fmac_f32 v44, v48, v48
    v_fmac_f32 v45, v49, v49
    v_fmac_f32 v46, v50, v50
    v_fmac_f32 v47, v51, v51
    s_waitcnt lgkmcnt(3)
    v_mfma_f32_32x32x16_bf16 v[20:35], v[80:83], v[68:71], v[20:35]
    v_lshlrev_b32 v48, 16, v70
    v_and_b32 v49, s64, v70
    v_lshlrev_b32 v50, 16, v71
    v_and_b32 v51, s64, v71
    v_mfma_f32_16x16x32_bf16 v[36:39], v[40:43], v[80:83], v[36:39]
    v_fmac_f32 v44, v48, v48
    v_fmac_f32 v45, v49, v49
    v_fmac_f32 v46, v50, v50
    v_fmac_f32 v47, v51, v51
    s_waitcnt lgkmcnt(0)
    s_barrier
    ds_read_b128 v[76:79], v6 offset:16384
    ds_read_b64_tr_b16 v[88:89], v10 offset:16384
    ds_read_b64_tr_b16 v[90:91], v10 offset:16896
    s_waitcnt lgkmcnt(3)
    v_mfma_f32_32x32x16_bf16 v[20:35], v[84:87], v[72:75], v[20:35]
    ds_read_b128 v[68:71], v7 offset:16384
    v_lshlrev_b32 v48, 16, v74
    v_and_b32 v49, s64, v74
    v_lshlrev_b32 v50, 16, v75
    v_and_b32 v51, s64, v75
    v_mfma_f32_16x16x32_bf16 v[36:39], v[40:43], v[84:87], v[36:39]
    ds_read_b64_tr_b16 v[80:81], v10 offset:18432
    ds_read_b64_tr_b16 v[82:83], v10 offset:18944
    v_fmac_f32 v44, v48, v48
    v_fmac_f32 v45, v49, v49
    v_fmac_f32 v46, v50, v50
    v_fmac_f32 v47, v51, v51
    s_waitcnt lgkmcnt(3)
    v_mfma_f32_32x32x16_bf16 v[20:35], v[88:91], v[76:79], v[20:35]
    ds_read_b128 v[72:75], v8 offset:16384
    v_lshlrev_b32 v48, 16, v78
    v_and_b32 v49, s64, v78
    v_lshlrev_b32 v50, 16, v79
    v_and_b32 v51, s64, v79
    v_mfma_f32_16x16x32_bf16 v[36:39], v[40:43], v[88:91], v[36:39]
    ds_read_b64_tr_b16 v[84:85], v10 offset:20480
    ds_read_b64_tr_b16 v[86:87], v10 offset:20992
    v_fmac_f32 v44, v48, v48
    v_fmac_f32 v45, v49, v49
    v_fmac_f32 v46, v50, v50
    v_fmac_f32 v47, v51, v51
    s_waitcnt lgkmcnt(3)
    v_mfma_f32_32x32x16_bf16 v[20:35], v[80:83], v[68:71], v[20:35]
    ds_read_b128 v[76:79], v9 offset:16384
    v_lshlrev_b32 v48, 16, v70
    v_and_b32 v49, s64, v70
    v_lshlrev_b32 v50, 16, v71
    v_and_b32 v51, s64, v71
    v_mfma_f32_16x16x32_bf16 v[36:39], v[40:43], v[80:83], v[36:39]
    ds_read_b64_tr_b16 v[88:89], v10 offset:22528
    ds_read_b64_tr_b16 v[90:91], v10 offset:23040
    v_fmac_f32 v44, v48, v48
    v_fmac_f32 v45, v49, v49
    v_fmac_f32 v46, v50, v50
    v_fmac_f32 v47, v51, v51
    s_waitcnt lgkmcnt(3)
    v_mfma_f32_32x32x16_bf16 v[20:35], v[84:87], v[72:75], v[20:35]
    v_lshlrev_b32 v48, 16, v74
    v_and_b32 v49, s64, v74
    v_lshlrev_b32 v50, 16, v75
    v_and_b32 v51, s64, v75
    v_mfma_f32_16x16x32_bf16 v[36:39], v[40:43], v[84:87], v[36:39]
    v_fmac_f32 v44, v48, v48
    v_fmac_f32 v45, v49, v49
    v_fmac_f32 v46, v50, v50
    v_fmac_f32 v47, v51, v51
    s_waitcnt lgkmcnt(0)
    s_barrier
    ds_read_b128 v[68:71], v6 offset:32768
    ds_read_b64_tr_b16 v[80:81], v10 offset:0
    ds_read_b64_tr_b16 v[82:83], v10 offset:512
    s_waitcnt lgkmcnt(3)
    v_mfma_f32_32x32x16_bf16 v[20:35], v[88:91], v[76:79], v[20:35]
    ds_read_b128 v[72:75], v7 offset:32768
    v_lshlrev_b32 v48, 16, v78
    v_and_b32 v49, s64, v78
    v_lshlrev_b32 v50, 16, v79
    v_and_b32 v51, s64, v79
    v_mfma_f32_16x16x32_bf16 v[36:39], v[40:43], v[88:91], v[36:39]
    ds_read_b64_tr_b16 v[84:85], v10 offset:2048
    ds_read_b64_tr_b16 v[86:87], v10 offset:2560
    v_fmac_f32 v44, v48, v48
    v_fmac_f32 v45, v49, v49
    v_fmac_f32 v46, v50, v50
    v_fmac_f32 v47, v51, v51
    s_waitcnt lgkmcnt(3)
    v_mfma_f32_32x32x16_bf16 v[20:35], v[80:83], v[68:71], v[20:35]
    ds_read_b128 v[76:79], v8 offset:32768
    v_lshlrev_b32 v48, 16, v70
    v_and_b32 v49, s64, v70
    v_lshlrev_b32 v50, 16, v71
    v_and_b32 v51, s64, v71
    v_mfma_f32_16x16x32_bf16 v[36:39], v[40:43], v[80:83], v[36:39]
    ds_read_b64_tr_b16 v[88:89], v10 offset:4096
    ds_read_b64_tr_b16 v[90:91], v10 offset:4608
    v_fmac_f32 v44, v48, v48
    v_fmac_f32 v45, v49, v49
    v_fmac_f32 v46, v50, v50
    v_fmac_f32 v47, v51, v51
    s_waitcnt lgkmcnt(3)
    v_mfma_f32_32x32x16_bf16 v[20:35], v[84:87], v[72:75], v[20:35]
    ds_read_b128 v[68:71], v9 offset:32768
    v_lshlrev_b32 v48, 16, v74
    v_and_b32 v49, s64, v74
    v_lshlrev_b32 v50, 16, v75
    v_and_b32 v51, s64, v75
    v_mfma_f32_16x16x32_bf16 v[36:39], v[40:43], v[84:87], v[36:39]
    ds_read_b64_tr_b16 v[80:81], v10 offset:6144
    ds_read_b64_tr_b16 v[82:83], v10 offset:6656
    v_fmac_f32 v44, v48, v48
    v_fmac_f32 v45, v49, v49
    v_fmac_f32 v46, v50, v50
    v_fmac_f32 v47, v51, v51
    s_waitcnt lgkmcnt(3)
    v_mfma_f32_32x32x16_bf16 v[20:35], v[88:91], v[76:79], v[20:35]
    v_lshlrev_b32 v48, 16, v78
    v_and_b32 v49, s64, v78
    v_lshlrev_b32 v50, 16, v79
    v_and_b32 v51, s64, v79
    v_mfma_f32_16x16x32_bf16 v[36:39], v[40:43], v[88:91], v[36:39]
    v_fmac_f32 v44, v48, v48
    v_fmac_f32 v45, v49, v49
    v_fmac_f32 v46, v50, v50
    v_fmac_f32 v47, v51, v51
    s_waitcnt lgkmcnt(0)
    v_mfma_f32_32x32x16_bf16 v[20:35], v[80:83], v[68:71], v[20:35]
    v_lshlrev_b32 v48, 16, v70
    v_and_b32 v49, s64, v70
    v_lshlrev_b32 v50, 16, v71
    v_and_b32 v51, s64, v71
    v_mfma_f32_16x16x32_bf16 v[36:39], v[40:43], v[80:83], v[36:39]
    v_fmac_f32 v44, v48, v48
    v_fmac_f32 v45, v49, v49
    v_fmac_f32 v46, v50, v50
    v_fmac_f32 v47, v51, v51
p1_j:
    v_pk_add_f32 v[44:45], v[44:45], v[46:47]
    v_add_f32 v3, v44, v45
    v_mov_b32 v5, v3
    s_nop 1
    v_permlane32_swap_b32 v5, v3
    v_add_f32 v3, v3, v5
    s_cmp_eq_u32 s34, 1
    v_mov_b32 v2, 0
    s_cbranch_scc0 p1_nosum
    v_mov_b32 v2, v32
p1_nosum:
    s_mov_b32 exec_lo, 0
    ds_write_b64 v14, v[2:3]
    s_mov_b64 exec, 0xffff
    ds_write2_b32 v16, v36, v37 offset0:0 offset1:16
    s_mov_b64 exec, -1
    s_waitcnt lgkmcnt(0)
    s_barrier
    ds_read_b64 v[2:3], v14
    ds_read_b64 v[4:5], v15
    ds_read_b128 v[92:95], v17 offset:0
    ds_read_b128 v[96:99], v17 offset:32
    ds_read_b128 v[100:103], v17 offset:64
    ds_read_b128 v[104:107], v17 offset:96
    s_waitcnt lgkmcnt(4)
    v_pk_add_f32 v[2:3], v[2:3], v[4:5]
    v_mul_f32 v2, 0xbb124925, v2
    v_mul_f32 v3, 0x3b124925, v3
    v_fma_f32 v3, -v2, v2, v3
    v_max_f32 v3, 0, v3
    v_add_f32 v3, 0x3727c5ac, v3
    v_rsq_f32 v3, v3
    s_waitcnt lgkmcnt(0)
    v_pk_fma_f32 v[20:21], v[92:93], v[2:3], v[20:21] op_sel_hi:[1,0,1]
    v_pk_fma_f32 v[22:23], v[94:95], v[2:3], v[22:23] op_sel_hi:[1,0,1]
    v_pk_fma_f32 v[24:25], v[96:97], v[2:3], v[24:25] op_sel_hi:[1,0,1]
    v_pk_fma_f32 v[26:27], v[98:99], v[2:3], v[26:27] op_sel_hi:[1,0,1]
    v_pk_fma_f32 v[28:29], v[100:101], v[2:3], v[28:29] op_sel_hi:[1,0,1]
    v_pk_fma_f32 v[30:31], v[102:103], v[2:3], v[30:31] op_sel_hi:[1,0,1]
    v_pk_fma_f32 v[32:33], v[104:105], v[2:3], v[32:33] op_sel_hi:[1,0,1]
    v_pk_fma_f32 v[34:35], v[106:107], v[2:3], v[34:35] op_sel_hi:[1,0,1]
    v_pk_mul_f32 v[20:21], v[20:21], v[2:3] op_sel:[0,1] op_sel_hi:[1,1]
    v_pk_mul_f32 v[22:23], v[22:23], v[2:3] op_sel:[0,1] op_sel_hi:[1,1]
    v_pk_mul_f32 v[24:25], v[24:25], v[2:3] op_sel:[0,1] op_sel_hi:[1,1]
    v_pk_mul_f32 v[26:27], v[26:27], v[2:3] op_sel:[0,1] op_sel_hi:[1,1]
    v_pk_mul_f32 v[28:29], v[28:29], v[2:3] op_sel:[0,1] op_sel_hi:[1,1]
    v_pk_mul_f32 v[30:31], v[30:31], v[2:3] op_sel:[0,1] op_sel_hi:[1,1]
    v_pk_mul_f32 v[32:33], v[32:33], v[2:3] op_sel:[0,1] op_sel_hi:[1,1]
    v_pk_mul_f32 v[34:35], v[34:35], v[2:3] op_sel:[0,1] op_sel_hi:[1,1]
    v_cvt_pk_bf16_f32 v68, v20, v21
    v_cvt_pk_bf16_f32 v69, v22, v23
    v_cvt_pk_bf16_f32 v70, v24, v25
    v_cvt_pk_bf16_f32 v71, v26, v27
    v_cvt_pk_bf16_f32 v72, v28, v29
    v_cvt_pk_bf16_f32 v73, v30, v31
    v_mov_b32 v74, 0x3f80
    v_mov_b32 v75, 0
    s_mov_b32 exec_hi, 0
    v_cvt_pk_bf16_f32 v74, v32, v33
    v_cvt_pk_bf16_f32 v75, v34, v35
    s_mov_b32 exec_hi, -1
    s_cmp_lt_u32 s35, 32
    s_cbranch_scc1 p1_st
    ds_write_b64 v19, v[68:69]
    ds_write_b64 v110, v[70:71]
    ds_write_b64 v111, v[72:73]
    ds_write_b64 v112, v[74:75]
    s_waitcnt lgkmcnt(0)
    ds_read_b64_tr_b16 v[68:69], v108 offset:0
    ds_read_b64_tr_b16 v[70:71], v109 offset:512
    ds_read_b64_tr_b16 v[72:73], v108 offset:1024
    ds_read_b64_tr_b16 v[74:75], v109 offset:1536
    s_waitcnt lgkmcnt(0)
p1_st:
    buffer_store_dwordx4 v[68:71], v1, s[12:15], s57 offen sc1
    buffer_store_dwordx4 v[72:75], v1, s[12:15], s57 offen offset:1024 sc1
    v_mov_b32 v20, 0
    v_mov_b32 v21, 0
    v_mov_b32 v22, 0
    v_mov_b32 v23, 0
    v_mov_b32 v24, 0
    v_mov_b32 v25, 0
    v_mov_b32 v26, 0
    v_mov_b32 v27, 0
    v_mov_b32 v28, 0
    v_mov_b32 v29, 0
    v_mov_b32 v30, 0
    v_mov_b32 v31, 0
    v_mov_b32 v32, 0
    v_mov_b32 v33, 0
    v_mov_b32 v34, 0
    v_mov_b32 v35, 0
    v_mov_b32 v36, 0
    v_mov_b32 v37, 0
    v_mov_b32 v38, 0
    v_mov_b32 v39, 0
    s_cmp_eq_u32 s34, 0
    s_cbranch_scc1 p1_q
    s_waitcnt vmcnt(0) lgkmcnt(0)
    s_barrier
    s_branch p1_done
p1_q:
    v_add_u32 v6, 0xffff0000, v6
    v_add_u32 v7, 0xffff0000, v7
    v_add_u32 v8, 0xffff0000, v8
    v_add_u32 v9, 0xffff0000, v9
    ds_read_b128 v[56:59], v6 offset:0
    ds_read_b64_tr_b16 v[80:81], v18 offset:16384
    ds_read_b64_tr_b16 v[82:83], v18 offset:16640
    ds_read_b128 v[60:63], v7 offset:0
    ds_read_b64_tr_b16 v[84:85], v18 offset:17408
    ds_read_b64_tr_b16 v[86:87], v18 offset:17664
    s_waitcnt lgkmcnt(3)
    v_mfma_f32_32x32x16_bf16 v[20:35], v[80:83], v[56:59], v[20:35]
    ds_read_b128 v[64:67], v8 offset:0
    v_mfma_f32_16x16x32_bf16 v[36:39], v[40:43], v[80:83], v[36:39]
    ds_read_b64_tr_b16 v[88:89], v18 offset:18432
    ds_read_b64_tr_b16 v[90:91], v18 offset:18688
    s_waitcnt lgkmcnt(3)
    v_mfma_f32_32x32x16_bf16 v[20:35], v[84:87], v[60:63], v[20:35]
    ds_read_b128 v[56:59], v9 offset:0
    v_mfma_f32_16x16x32_bf16 v[36:39], v[40:43], v[84:87], v[36:39]
    ds_read_b64_tr_b16 v[80:81], v18 offset:19456
    ds_read_b64_tr_b16 v[82:83], v18 offset:19712
    s_waitcnt lgkmcnt(3)
    v_mfma_f32_32x32x16_bf16 v[20:35], v[88:91], v[64:67], v[20:35]
    ds_read_b128 v[60:63], v6 offset:16384
    v_mfma_f32_16x16x32_bf16 v[36:39], v[40:43], v[88:91], v[36:39]
    ds_read_b64_tr_b16 v[84:85], v18 offset:20480
    ds_read_b64_tr_b16 v[86:87], v18 offset:20736
    s_waitcnt lgkmcnt(3)
    v_mfma_f32_32x32x16_bf16 v[20:35], v[80:83], v[56:59], v[20:35]
    ds_read_b128 v[64:67], v7 offset:16384
    v_mfma_f32_16x16x32_bf16 v[36:39], v[40:43], v[80:83], v[36:39]
    ds_read_b64_tr_b16 v[88:89], v18 offset:21504
    ds_read_b64_tr_b16 v[90:91], v18 offset:21760
    s_waitcnt lgkmcnt(3)
    v_mfma_f32_32x32x16_bf16 v[20:35], v[84:87], v[60:63], v[20:35]
    ds_read_b128 v[56:59], v8 offset:16384
    v_mfma_f32_16x16x32_bf16 v[36:39], v[40:43], v[84:87], v[36:39]
    ds_read_b64_tr_b16 v[80:81], v18 offset:22528
    ds_read_b64_tr_b16 v[82:83], v18 offset:22784
    s_waitcnt lgkmcnt(3)
    v_mfma_f32_32x32x16_bf16 v[20:35], v[88:91], v[64:67], v[20:35]
    ds_read_b128 v[60:63], v9 offset:16384
    v_mfma_f32_16x16x32_bf16 v[36:39], v[40:43], v[88:91], v[36:39]
    ds_read_b64_tr_b16 v[84:85], v18 offset:23552
    ds_read_b64_tr_b16 v[86:87], v18 offset:23808
    s_waitcnt lgkmcnt(3)
    v_mfma_f32_32x32x16_bf16 v[20:35], v[80:83], v[56:59], v[20:35]
    ds_read_b128 v[64:67], v6 offset:32768
    v_mfma_f32_16x16x32_bf16 v[36:39], v[40:43], v[80:83], v[36:39]
    ds_read_b64_tr_b16 v[88:89], v18 offset:24576
    ds_read_b64_tr_b16 v[90:91], v18 offset:24832
    s_waitcnt lgkmcnt(3)
    v_mfma_f32_32x32x16_bf16 v[20:35], v[84:87], v[60:63], v[20:35]
    ds_read_b128 v[56:59], v7 offset:32768
    v_mfma_f32_16x16x32_bf16 v[36:39], v[40:43], v[84:87], v[36:39]
    ds_read_b64_tr_b16 v[80:81], v18 offset:25600
    ds_read_b64_tr_b16 v[82:83], v18 offset:25856
    s_waitcnt lgkmcnt(3)
    v_mfma_f32_32x32x16_bf16 v[20:35], v[88:91], v[64:67], v[20:35]
    s_waitcnt vmcnt(0)
    s_barrier
    ds_read_b128 v[60:63], v8 offset:32768
    v_mfma_f32_16x16x32_bf16 v[36:39], v[40:43], v[88:91], v[36:39]
    ds_read_b64_tr_b16 v[84:85], v18 offset:26624
    ds_read_b64_tr_b16 v[86:87], v18 offset:26880
    s_waitcnt lgkmcnt(3)
    v_mfma_f32_32x32x16_bf16 v[20:35], v[80:83], v[56:59], v[20:35]
    ds_read_b128 v[64:67], v9 offset:32768
    v_mfma_f32_16x16x32_bf16 v[36:39], v[40:43], v[80:83], v[36:39]
    ds_read_b64_tr_b16 v[88:89], v18 offset:27648
    ds_read_b64_tr_b16 v[90:91], v18 offset:27904
    s_waitcnt lgkmcnt(3)
    v_mfma_f32_32x32x16_bf16 v[20:35], v[84:87], v[60:63], v[20:35]
    ds_read_b128 v[56:59], v6 offset:49152
    v_mfma_f32_16x16x32_bf16 v[36:39], v[40:43], v[84:87], v[36:39]
    ds_read_b64_tr_b16 v[80:81], v18 offset:28672
    ds_read_b64_tr_b16 v[82:83], v18 offset:28928
    s_waitcnt lgkmcnt(3)
    v_mfma_f32_32x32x16_bf16 v[20:35], v[88:91], v[64:67], v[20:35]
    ds_read_b128 v[60:63], v7 offset:49152
    v_mfma_f32_16x16x32_bf16 v[36:39], v[40:43], v[88:91], v[36:39]
    ds_read_b64_tr_b16 v[84:85], v18 offset:29696
    ds_read_b64_tr_b16 v[86:87], v18 offset:29952
    s_waitcnt lgkmcnt(3)
    v_mfma_f32_32x32x16_bf16 v[20:35], v[80:83], v[56:59], v[20:35]
    ds_read_b128 v[64:67], v8 offset:49152
    v_mfma_f32_16x16x32_bf16 v[36:39], v[40:43], v[80:83], v[36:39]
    ds_read_b64_tr_b16 v[88:89], v18 offset:30720
    ds_read_b64_tr_b16 v[90:91], v18 offset:30976
    s_waitcnt lgkmcnt(3)
    v_mfma_f32_32x32x16_bf16 v[20:35], v[84:87], v[60:63], v[20:35]
    ds_read_b128 v[56:59], v9 offset:49152
    v_mfma_f32_16x16x32_bf16 v[36:39], v[40:43], v[84:87], v[36:39]
    ds_read_b64_tr_b16 v[80:81], v18 offset:31744
    ds_read_b64_tr_b16 v[82:83], v18 offset:32000
    s_waitcnt lgkmcnt(3)
    v_mfma_f32_32x32x16_bf16 v[20:35], v[88:91], v[64:67], v[20:35]
    v_add_u32 v6, 0x10000, v6
    v_add_u32 v7, 0x10000, v7
    v_add_u32 v8, 0x10000, v8
    v_add_u32 v9, 0x10000, v9
    ds_read_b128 v[60:63], v6 offset:0
    v_mfma_f32_16x16x32_bf16 v[36:39], v[40:43], v[88:91], v[36:39]
    ds_read_b64_tr_b16 v[84:85], v18 offset:32768
    ds_read_b64_tr_b16 v[86:87], v18 offset:33024
    s_waitcnt lgkmcnt(3)
    v_mfma_f32_32x32x16_bf16 v[20:35], v[80:83], v[56:59], v[20:35]
    ds_read_b128 v[64:67], v7 offset:0
    v_mfma_f32_16x16x32_bf16 v[36:39], v[40:43], v[80:83], v[36:39]
    ds_read_b64_tr_b16 v[88:89], v18 offset:33792
    ds_read_b64_tr_b16 v[90:91], v18 offset:34048
    s_waitcnt lgkmcnt(3)
    v_mfma_f32_32x32x16_bf16 v[20:35], v[84:87], v[60:63], v[20:35]
    ds_read_b128 v[56:59], v8 offset:0
    v_mfma_f32_16x16x32_bf16 v[36:39], v[40:43], v[84:87], v[36:39]
    ds_read_b64_tr_b16 v[80:81], v18 offset:34816
    ds_read_b64_tr_b16 v[82:83], v18 offset:35072
    s_waitcnt lgkmcnt(3)
    v_mfma_f32_32x32x16_bf16 v[20:35], v[88:91], v[64:67], v[20:35]
    ds_read_b128 v[60:63], v9 offset:0
    v_mfma_f32_16x16x32_bf16 v[36:39], v[40:43], v[88:91], v[36:39]
    ds_read_b64_tr_b16 v[84:85], v18 offset:35840
    ds_read_b64_tr_b16 v[86:87], v18 offset:36096
    s_waitcnt lgkmcnt(3)
    v_mfma_f32_32x32x16_bf16 v[20:35], v[80:83], v[56:59], v[20:35]
    ds_read_b128 v[64:67], v6 offset:16384
    v_mfma_f32_16x16x32_bf16 v[36:39], v[40:43], v[80:83], v[36:39]
    ds_read_b64_tr_b16 v[88:89], v18 offset:0
    ds_read_b64_tr_b16 v[90:91], v18 offset:256
    s_waitcnt lgkmcnt(3)
    v_mfma_f32_32x32x16_bf16 v[20:35], v[84:87], v[60:63], v[20:35]
    ds_read_b128 v[56:59], v7 offset:16384
    v_mfma_f32_16x16x32_bf16 v[36:39], v[40:43], v[84:87], v[36:39]
    ds_read_b64_tr_b16 v[80:81], v18 offset:1024
    ds_read_b64_tr_b16 v[82:83], v18 offset:1280
    s_waitcnt lgkmcnt(3)
    v_mfma_f32_32x32x16_bf16 v[20:35], v[88:91], v[64:67], v[20:35]
    ds_read_b128 v[60:63], v8 offset:16384
    v_mfma_f32_16x16x32_bf16 v[36:39], v[40:43], v[88:91], v[36:39]
    ds_read_b64_tr_b16 v[84:85], v18 offset:2048
    ds_read_b64_tr_b16 v[86:87], v18 offset:2304
    s_waitcnt lgkmcnt(3)
    v_mfma_f32_32x32x16_bf16 v[20:35], v[80:83], v[56:59], v[20:35]
    ds_read_b128 v[64:67], v9 offset:16384
    v_mfma_f32_16x16x32_bf16 v[36:39], v[40:43], v[80:83], v[36:39]
    ds_read_b64_tr_b16 v[88:89], v18 offset:3072
    ds_read_b64_tr_b16 v[90:91], v18 offset:3328
    s_waitcnt lgkmcnt(3)
    v_mfma_f32_32x32x16_bf16 v[20:35], v[84:87], v[60:63], v[20:35]
    ds_read_b128 v[56:59], v6 offset:32768
    v_mfma_f32_16x16x32_bf16 v[36:39], v[40:43], v[84:87], v[36:39]
    ds_read_b64_tr_b16 v[80:81], v18 offset:4096
    ds_read_b64_tr_b16 v[82:83], v18 offset:4352
    s_waitcnt lgkmcnt(3)
    v_mfma_f32_32x32x16_bf16 v[20:35], v[88:91], v[64:67], v[20:35]
    ds_read_b128 v[60:63], v7 offset:32768
    v_mfma_f32_16x16x32_bf16 v[36:39], v[40:43], v[88:91], v[36:39]
    ds_read_b64_tr_b16 v[84:85], v18 offset:5120
    ds_read_b64_tr_b16 v[86:87], v18 offset:5376
    s_waitcnt lgkmcnt(3)
    v_mfma_f32_32x32x16_bf16 v[20:35], v[80:83], v[56:59], v[20:35]
    ds_read_b128 v[64:67], v8 offset:32768
    v_mfma_f32_16x16x32_bf16 v[36:39], v[40:43], v[80:83], v[36:39]
    ds_read_b64_tr_b16 v[88:89], v18 offset:6144
    ds_read_b64_tr_b16 v[90:91], v18 offset:6400
    s_waitcnt lgkmcnt(3)
    v_mfma_f32_32x32x16_bf16 v[20:35], v[84:87], v[60:63], v[20:35]
    ds_read_b128 v[56:59], v9 offset:32768
    v_mfma_f32_16x16x32_bf16 v[36:39], v[40:43], v[84:87], v[36:39]
    ds_read_b64_tr_b16 v[80:81], v18 offset:7168
    ds_read_b64_tr_b16 v[82:83], v18 offset:7424
    s_waitcnt lgkmcnt(3)
    v_mfma_f32_32x32x16_bf16 v[20:35], v[88:91], v[64:67], v[20:35]
    v_mfma_f32_16x16x32_bf16 v[36:39], v[40:43], v[88:91], v[36:39]
    s_waitcnt lgkmcnt(0)
    v_mfma_f32_32x32x16_bf16 v[20:35], v[80:83], v[56:59], v[20:35]
    v_mfma_f32_16x16x32_bf16 v[36:39], v[40:43], v[80:83], v[36:39]
    v_mul_f32 v4, 0x3e8b97f6, v3
    s_lshl_b32 s6, s58, 11
    s_add_u32 s6, s6, 114688
    v_add_u32 v19, s6, v1
    s_mov_b64 exec, 0xffff
    s_nop 2
    ds_write2_b32 v16, v36, v37 offset0:0 offset1:16
    s_mov_b64 exec, -1
    s_waitcnt lgkmcnt(0)
    ds_read_b128 v[92:95], v17 offset:0
    ds_read_b128 v[96:99], v17 offset:32
    ds_read_b128 v[100:103], v17 offset:64
    ds_read_b128 v[104:107], v17 offset:96
    s_waitcnt lgkmcnt(0)
    v_pk_fma_f32 v[20:21], v[92:93], v[2:3], v[20:21] op_sel_hi:[1,0,1]
    v_pk_fma_f32 v[22:23], v[94:95], v[2:3], v[22:23] op_sel_hi:[1,0,1]
    v_pk_fma_f32 v[24:25], v[96:97], v[2:3], v[24:25] op_sel_hi:[1,0,1]
    v_pk_fma_f32 v[26:27], v[98:99], v[2:3], v[26:27] op_sel_hi:[1,0,1]
    v_pk_fma_f32 v[28:29], v[100:101], v[2:3], v[28:29] op_sel_hi:[1,0,1]
    v_pk_fma_f32 v[30:31], v[102:103], v[2:3], v[30:31] op_sel_hi:[1,0,1]
    v_pk_fma_f32 v[32:33], v[104:105], v[2:3], v[32:33] op_sel_hi:[1,0,1]
    v_pk_fma_f32 v[34:35], v[106:107], v[2:3], v[34:35] op_sel_hi:[1,0,1]
    v_pk_mul_f32 v[20:21], v[20:21], v[4:5] op_sel_hi:[1,0]
    v_pk_mul_f32 v[22:23], v[22:23], v[4:5] op_sel_hi:[1,0]
    v_pk_mul_f32 v[24:25], v[24:25], v[4:5] op_sel_hi:[1,0]
    v_pk_mul_f32 v[26:27], v[26:27], v[4:5] op_sel_hi:[1,0]
    v_pk_mul_f32 v[28:29], v[28:29], v[4:5] op_sel_hi:[1,0]
    v_pk_mul_f32 v[30:31], v[30:31], v[4:5] op_sel_hi:[1,0]
    v_pk_mul_f32 v[32:33], v[32:33], v[4:5] op_sel_hi:[1,0]
    v_pk_mul_f32 v[34:35], v[34:35], v[4:5] op_sel_hi:[1,0]
    v_cvt_pk_bf16_f32 v68, v20, v21
    v_cvt_pk_bf16_f32 v69, v22, v23
    v_cvt_pk_bf16_f32 v70, v24, v25
    v_cvt_pk_bf16_f32 v71, v26, v27
    v_cvt_pk_bf16_f32 v72, v28, v29
    v_cvt_pk_bf16_f32 v73, v30, v31
    v_mov_b32 v74, 0
    v_mov_b32 v75, 0
    s_mov_b32 exec_hi, 0
    v_cvt_pk_bf16_f32 v74, v32, v33
    v_cvt_pk_bf16_f32 v75, v34, v35
    s_mov_b32 exec_hi, -1
    ds_write_b128 v19, v[68:71]
    ds_write_b128 v19, v[72:75] offset:1024
p1_done:
    s_and_b32 s6, s4, 1
    s_lshl_b32 s6, s6, 3
    s_and_b32 s7, s5, 7
    s_add_u32 s32, s6, s7
    s_lshr_b32 s6, s4, 1
    s_lshl_b32 s6, s6, 2
    s_lshr_b32 s56, s5, 3
    s_add_u32 s33, s6, s56
    s_lshr_b32 s34, s3, 2
    s_lshl_b32 s6, s32, 17
    s_add_u32 s8, s54, 0x200000
    s_addc_u32 s9, s55, 0
    s_mov_b32 s10, 0x20000
    s_mov_b32 s11, 0x20000
    s_add_u32 s8, s8, s6
    s_addc_u32 s9, s9, 0
    s_add_u32 s12, s54, 0x400000
    s_addc_u32 s13, s55, 0
    s_mov_b32 s14, 0x20000
    s_mov_b32 s15, 0x20000
    s_add_u32 s12, s12, s6
    s_addc_u32 s13, s13, 0
    s_lshl_b32 s6, s33, 2
    s_add_u32 s65, s6, s58
    s_add_u32 s20, s54, 0x600000
    s_addc_u32 s21, s55, 0
    s_mov_b32 s22, 0x400
    s_mov_b32 s23, 0x20000
    s_and_b32 s6, s65, 31
    s_mul_i32 s6, s6, 65536
    s_add_u32 s20, s20, s6
    s_addc_u32 s21, s21, 0
    s_add_u32 s66, s54, 0x600000
    s_add_u32 s66, s66, s6
    s_lshr_b32 s66, s66, 19
    s_xor_b32 s66, s66, s4
    s_and_b32 s66, s66, 4
    s_lshl_b32 s66, s66, 11
    s_lshl_b32 s6, s32, 1
    s_add_u32 s6, s6, s34
    s_lshr_b32 s7, s6, 3
    s_lshl_b32 s7, s7, 3
    s_add_u32 s6, s6, s7
    s_lshl_b32 s6, s6, 10
    s_add_u32 s20, s20, s6
    s_addc_u32 s21, s21, 0
    s_lshl_b32 s6, s34, 14
    v_add_u32 v2, s6, v1
    v_add_u32 v3, 32768, v2
    v_mov_b32 v100, v2
    v_mov_b32 v104, 163824
    s_mov_b32 s64, 32768
    s_mul_i32 s6, s3, 3072
    v_add_u32 v101, s6, v1
    s_xor_b32 s6, s3, 4
    s_mul_i32 s6, s6, 3072
    v_add_u32 v102, s6, v1
    v_mov_b32 v84, 0
    v_mov_b32 v85, 0
    v_mov_b32 v86, 0
    v_mov_b32 v87, 0
    v_mov_b32 v88, 0
    v_mov_b32 v89, 0
    v_mov_b32 v90, 0
    v_mov_b32 v91, 0
    v_mov_b32 v92, 0
    v_mov_b32 v93, 0
    v_mov_b32 v94, 0
    v_mov_b32 v95, 0
    v_mov_b32 v96, 0
    v_mov_b32 v97, 0
    v_mov_b32 v98, 0
    v_mov_b32 v99, 0
    v_mov_b32 v80, 0
    v_mov_b32 v81, 0
    v_mov_b32 v82, 0
    v_mov_b32 v83, 0
    s_mov_b32 s35, 0
    s_lshl_b32 s6, s58, 11
    s_add_u32 s6, s6, 114688
    v_add_u32 v12, s6, v1
    s_waitcnt lgkmcnt(0)
    s_barrier
    ds_read_b128 v[4:7], v12
    ds_read_b128 v[8:11], v12 offset:1024
    s_waitcnt lgkmcnt(0)
    s_barrier
    ds_read_b128 v[36:39], v1
    ds_read_b128 v[40:43], v1 offset:1024
    ds_read_b128 v[12:15], v2 offset:0
    ds_read_b128 v[16:19], v2 offset:1024
    ds_read_b128 v[20:23], v2 offset:4096
    ds_read_b128 v[24:27], v2 offset:5120
    s_waitcnt lgkmcnt(4)
    v_mfma_f32_32x32x16_bf16 v[60:75], v[36:39], v[4:7], 0
    v_mfma_f32_32x32x16_bf16 v[60:75], v[40:43], v[8:11], v[60:75]
    s_waitcnt lgkmcnt(2)
    v_mfma_f32_32x32x16_bf16 v[44:59], v[12:15], v[4:7], 0
    s_nop 9
    v_max3_f32 v76, v60, v61, v62
    v_max3_f32 v77, v63, v64, v65
    v_max3_f32 v76, v76, v66, v67
    v_max3_f32 v77, v77, v68, v69
    v_max3_f32 v76, v76, v70, v71
    v_max3_f32 v77, v77, v72, v73
    v_max3_f32 v76, v76, v74, v75
    v_max_f32 v76, v76, v77
    v_mov_b32 v77, v76
    s_nop 1
    v_permlane32_swap_b32 v77, v76
    v_max_f32 v76, v76, v77
    s_mov_b32 exec_lo, 0
    v_cvt_pk_bf16_f32 v10, -v76, 0
    s_mov_b32 exec_lo, -1
    s_nop 0
    v_mfma_f32_32x32x16_bf16 v[44:59], v[16:19], v[8:11], v[44:59]
    s_barrier
    ds_read_b128 v[28:31], v2 offset:2048
    ds_read_b128 v[32:35], v2 offset:3072
    s_nop 4
attn_loop:
    s_setprio 2
    s_waitcnt lgkmcnt(0)
    v_mfma_f32_32x32x16_bf16 v[60:75], v[20:23], v[4:7], 0
    s_nop 0
    v_exp_f32 v44, v44
    v_exp_f32 v45, v45
    v_exp_f32 v46, v46
    v_exp_f32 v47, v47
    v_mfma_f32_32x32x16_bf16 v[84:99], v[40:43], v[80:83], v[84:99]
    v_exp_f32 v48, v48
    v_exp_f32 v49, v49
    v_exp_f32 v50, v50
    ds_read_b128 v[12:15], v2 offset:8192
    ds_read_b128 v[16:19], v2 offset:9216
    v_exp_f32 v51, v51
    v_mfma_f32_32x32x16_bf16 v[60:75], v[24:27], v[8:11], v[60:75]
    ds_read_b128 v[36:39], v2 offset:6144
    ds_read_b128 v[40:43], v2 offset:7168
    v_exp_f32 v52, v52
    v_cvt_pk_bf16_f32 v76, v44, v45
    v_cvt_pk_bf16_f32 v77, v46, v47
    v_cvt_pk_bf16_f32 v78, v48, v49
    v_cvt_pk_bf16_f32 v79, v50, v51
    v_exp_f32 v53, v53
    v_exp_f32 v54, v54
    v_mfma_f32_32x32x16_bf16 v[84:99], v[28:31], v[76:79], v[84:99]
    v_exp_f32 v55, v55
    v_exp_f32 v56, v56
    v_exp_f32 v57, v57
    v_exp_f32 v58, v58
    v_exp_f32 v59, v59
    v_cvt_pk_bf16_f32 v80, v52, v53
    v_cvt_pk_bf16_f32 v81, v54, v55
    v_cvt_pk_bf16_f32 v82, v56, v57
    v_cvt_pk_bf16_f32 v83, v58, v59
    s_setprio 1
    s_waitcnt lgkmcnt(0)
    v_mfma_f32_32x32x16_bf16 v[44:59], v[12:15], v[4:7], 0
    v_exp_f32 v60, v60
    v_exp_f32 v61, v61
    v_exp_f32 v62, v62
    v_exp_f32 v63, v63
    v_mfma_f32_32x32x16_bf16 v[84:99], v[32:35], v[80:83], v[84:99]
    v_exp_f32 v64, v64
    v_exp_f32 v65, v65
    v_exp_f32 v66, v66
    ds_read_b128 v[20:23], v2 offset:12288
    ds_read_b128 v[24:27], v2 offset:13312
    v_exp_f32 v67, v67
    v_mfma_f32_32x32x16_bf16 v[44:59], v[16:19], v[8:11], v[44:59]
    ds_read_b128 v[28:31], v2 offset:10240
    ds_read_b128 v[32:35], v2 offset:11264
    v_exp_f32 v68, v68
    v_cvt_pk_bf16_f32 v76, v60, v61
    v_cvt_pk_bf16_f32 v77, v62, v63
    v_cvt_pk_bf16_f32 v78, v64, v65
    v_cvt_pk_bf16_f32 v79, v66, v67
    v_exp_f32 v69, v69
    v_exp_f32 v70, v70
    v_mfma_f32_32x32x16_bf16 v[84:99], v[36:39], v[76:79], v[84:99]
    v_exp_f32 v71, v71
    v_exp_f32 v72, v72
    v_exp_f32 v73, v73
    v_exp_f32 v74, v74
    v_exp_f32 v75, v75
    s_add_u32 s64, s64, 32768
    s_cmp_eq_u32 s64, 98304
    s_cselect_b32 s64, 0, s64
    v_cvt_pk_bf16_f32 v80, v68, v69
    v_cvt_pk_bf16_f32 v81, v70, v71
    v_cvt_pk_bf16_f32 v82, v72, v73
    v_cvt_pk_bf16_f32 v83, v74, v75
    s_setprio 0
    s_waitcnt lgkmcnt(0)
    v_mfma_f32_32x32x16_bf16 v[60:75], v[20:23], v[4:7], 0
    v_exp_f32 v44, v44
    v_exp_f32 v45, v45
    v_exp_f32 v46, v46
    v_exp_f32 v47, v47
    v_mfma_f32_32x32x16_bf16 v[84:99], v[40:43], v[80:83], v[84:99]
    v_exp_f32 v48, v48
    v_exp_f32 v49, v49
    s_barrier
    v_exp_f32 v50, v50
    ds_read_b128 v[12:15], v3 offset:0
    ds_read_b128 v[16:19], v3 offset:1024
    v_exp_f32 v51, v51
    v_mfma_f32_32x32x16_bf16 v[60:75], v[24:27], v[8:11], v[60:75]
    ds_read_b128 v[36:39], v2 offset:14336
    ds_read_b128 v[40:43], v2 offset:15360
    ds_read_b32 v103, v104
    v_exp_f32 v52, v52
    v_cvt_pk_bf16_f32 v76, v44, v45
    v_cvt_pk_bf16_f32 v77, v46, v47
    v_cvt_pk_bf16_f32 v78, v48, v49
    v_cvt_pk_bf16_f32 v79, v50, v51
    v_exp_f32 v53, v53
    v_exp_f32 v54, v54
    v_mfma_f32_32x32x16_bf16 v[84:99], v[28:31], v[76:79], v[84:99]
    v_exp_f32 v55, v55
    v_exp_f32 v56, v56
    v_exp_f32 v57, v57
    v_exp_f32 v58, v58
    v_exp_f32 v59, v59
    v_cvt_pk_bf16_f32 v80, v52, v53
    v_cvt_pk_bf16_f32 v81, v54, v55
    v_cvt_pk_bf16_f32 v82, v56, v57
    v_cvt_pk_bf16_f32 v83, v58, v59
    s_setprio 3
    s_waitcnt lgkmcnt(0)
    v_mfma_f32_32x32x16_bf16 v[44:59], v[12:15], v[4:7], 0
    v_exp_f32 v60, v60
    v_exp_f32 v61, v61
    v_exp_f32 v62, v62
    v_exp_f32 v63, v63
    v_mfma_f32_32x32x16_bf16 v[84:99], v[32:35], v[80:83], v[84:99]
    v_exp_f32 v64, v64
    v_exp_f32 v65, v65
    v_exp_f32 v66, v66
    ds_read_b128 v[20:23], v3 offset:4096
    ds_read_b128 v[24:27], v3 offset:5120
    v_exp_f32 v67, v67
    v_mfma_f32_32x32x16_bf16 v[44:59], v[16:19], v[8:11], v[44:59]
    ds_read_b128 v[28:31], v3 offset:2048
    ds_read_b128 v[32:35], v3 offset:3072
    v_exp_f32 v68, v68
    v_cvt_pk_bf16_f32 v76, v60, v61
    v_cvt_pk_bf16_f32 v77, v62, v63
    v_cvt_pk_bf16_f32 v78, v64, v65
    v_cvt_pk_bf16_f32 v79, v66, v67
    v_exp_f32 v69, v69
    v_exp_f32 v70, v70
    v_mfma_f32_32x32x16_bf16 v[84:99], v[36:39], v[76:79], v[84:99]
    v_exp_f32 v71, v71
    v_exp_f32 v72, v72
    v_exp_f32 v73, v73
    v_exp_f32 v74, v74
    v_exp_f32 v75, v75
    v_mov_b32 v2, v3
    v_add_u32 v3, s64, v100
    s_add_u32 s35, s35, 1
    s_cmp_lt_u32 s35, 8
    v_cvt_pk_bf16_f32 v80, v68, v69
    v_cvt_pk_bf16_f32 v81, v70, v71
    v_cvt_pk_bf16_f32 v82, v72, v73
    v_cvt_pk_bf16_f32 v83, v74, v75
    s_cbranch_scc1 attn_loop
    s_nop 0
    v_mfma_f32_32x32x16_bf16 v[84:99], v[40:43], v[80:83], v[84:99]
    s_setprio 0
    s_mov_b32 s6, 0x5d800000
    s_mov_b32 s7, 0x21800000
    v_readfirstlane_b32 s88, v103
    s_nop 0
    s_lshl_b32 s67, s88, 11
    s_xor_b32 s66, s66, s67
    s_add_u32 s20, s20, s66
    s_addc_u32 s21, s21, 0
    s_waitcnt lgkmcnt(0)
    s_cmp_eq_u32 s34, 1
    s_cbranch_scc1 attn_h1
    s_nop 2
    ds_write_b128 v101, v[92:95] offset:0
    ds_write_b128 v101, v[96:99] offset:1024
    s_waitcnt lgkmcnt(0)
    s_barrier
    ds_read_b128 v[44:47], v102 offset:0
    ds_read_b128 v[48:51], v102 offset:1024
    ds_read_b32 v60, v102 offset:2048
    s_waitcnt lgkmcnt(0)
    v_pk_add_f32 v[84:85], v[84:85], v[44:45]
    v_pk_add_f32 v[86:87], v[86:87], v[46:47]
    v_pk_add_f32 v[88:89], v[88:89], v[48:49]
    v_pk_add_f32 v[90:91], v[90:91], v[50:51]
    v_add_f32 v60, v60, v96
attn_norm0:
    v_mov_b32 v62, v60
    s_nop 1
    v_permlane32_swap_b32 v62, v60
    v_rcp_f32 v62, v60
    v_cmp_nle_f32 s[72:73], v60, s6
    v_cmp_nge_f32 s[74:75], v60, s7
    v_pk_mul_f32 v[84:85], v[84:85], v[62:63] op_sel_hi:[1,0]
    v_pk_mul_f32 v[86:87], v[86:87], v[62:63] op_sel_hi:[1,0]
    v_pk_mul_f32 v[88:89], v[88:89], v[62:63] op_sel_hi:[1,0]
    v_pk_mul_f32 v[90:91], v[90:91], v[62:63] op_sel_hi:[1,0]
    v_pk_mul_f32 v[64:65], v[84:85], 0
    v_pk_fma_f32 v[64:65], v[86:87], 0, v[64:65]
    v_pk_fma_f32 v[64:65], v[88:89], 0, v[64:65]
    v_pk_fma_f32 v[64:65], v[90:91], 0, v[64:65]
    v_cvt_pk_bf16_f32 v76, v84, v85
    v_cvt_pk_bf16_f32 v77, v86, v87
    v_cvt_pk_bf16_f32 v78, v88, v89
    v_cvt_pk_bf16_f32 v79, v90, v91
    v_cmp_u_f32 vcc, v64, v65
    s_or_b64 s[72:73], s[72:73], s[74:75]
    s_or_b64 s[72:73], s[72:73], vcc
    s_cmp_eq_u32 s35, 8
    s_cselect_b64 s[72:73], s[72:73], 0
    s_cmp_lg_u64 s[72:73], 0
    s_cbranch_scc1 attn_slow
    s_branch attn_join
attn_h1:
    s_nop 2
    ds_write_b128 v101, v[84:87] offset:0
    ds_write_b128 v101, v[88:91] offset:1024
    ds_write_b32 v101, v96 offset:2048
    s_waitcnt lgkmcnt(0)
    s_barrier
    ds_read_b128 v[44:47], v102 offset:0
    ds_read_b128 v[48:51], v102 offset:1024
    s_waitcnt lgkmcnt(0)
    v_pk_add_f32 v[92:93], v[92:93], v[44:45]
    v_pk_add_f32 v[94:95], v[94:95], v[46:47]
    v_pk_add_f32 v[96:97], v[96:97], v[48:49]
    v_pk_add_f32 v[98:99], v[98:99], v[50:51]
    v_mov_b32 v60, v96
attn_norm1:
    v_mov_b32 v62, v60
    s_nop 1
    v_permlane32_swap_b32 v62, v60
    v_rcp_f32 v62, v60
    s_mov_b32 exec_lo, 0
    v_mov_b32 v96, 0
    v_mov_b32 v97, 0
    v_mov_b32 v98, 0
    v_mov_b32 v99, 0
    s_mov_b32 exec_lo, -1
    v_cmp_nle_f32 s[72:73], v60, s6
    v_cmp_nge_f32 s[74:75], v60, s7
    v_pk_mul_f32 v[92:93], v[92:93], v[62:63] op_sel_hi:[1,0]
    v_pk_mul_f32 v[94:95], v[94:95], v[62:63] op_sel_hi:[1,0]
    v_pk_mul_f32 v[96:97], v[96:97], v[62:63] op_sel_hi:[1,0]
    v_pk_mul_f32 v[98:99], v[98:99], v[62:63] op_sel_hi:[1,0]
    v_pk_mul_f32 v[64:65], v[92:93], 0
    v_pk_fma_f32 v[64:65], v[94:95], 0, v[64:65]
    v_pk_fma_f32 v[64:65], v[96:97], 0, v[64:65]
    v_pk_fma_f32 v[64:65], v[98:99], 0, v[64:65]
    v_cvt_pk_bf16_f32 v76, v92, v93
    v_cvt_pk_bf16_f32 v77, v94, v95
    v_cvt_pk_bf16_f32 v78, v96, v97
    v_cvt_pk_bf16_f32 v79, v98, v99
    v_cmp_u_f32 vcc, v64, v65
    s_or_b64 s[72:73], s[72:73], s[74:75]
    s_or_b64 s[72:73], s[72:73], vcc
    s_cmp_eq_u32 s35, 8
    s_cselect_b64 s[72:73], s[72:73], 0
    s_cmp_lg_u64 s[72:73], 0
    s_cbranch_scc1 attn_slow
attn_join:
    buffer_store_dwordx4 v[76:79], v1, s[20:23], 0 offen sc1
    s_waitcnt vmcnt(0) lgkmcnt(0)
    s_barrier
    s_cmp_ge_u32 s5, 28
    s_cbranch_scc1 colsum
    s_cmp_ge_u32 s3, 4
    s_cbranch_scc1 p3_idle
    s_lshl_b32 s6, s4, 2
    s_and_b32 s32, s5, 3
    s_add_u32 s32, s32, s6
    s_lshr_b32 s33, s5, 2
    s_lshr_b32 s56, s58, 1
    s_lshl_b32 s64, s32, 1
    s_add_u32 s64, s64, s56
    s_and_b32 s57, s58, 1
    s_lshl_b32 s65, s33, 1
    s_add_u32 s65, s65, s57
    v_and_b32 v6, 31, v0
    v_mul_u32_u24 v4, 896, v6
    v_lshrrev_b32 v6, 5, v0
    v_lshl_add_u32 v4, v6, 3, v4
    s_mov_b32 s12, s36
    s_mov_b32 s13, s37
    s_mov_b32 s14, 0x1c0000
    s_mov_b32 s15, 0x20000
    s_mul_i32 s6, s64, 28672
    s_lshl_b32 s7, s65, 6
    s_add_u32 s6, s6, s7
    buffer_load_dwordx2 v[28:29], v4, s[12:15], s6 offen offset:0
    buffer_load_dwordx2 v[30:31], v4, s[12:15], s6 offen offset:16
    buffer_load_dwordx2 v[32:33], v4, s[12:15], s6 offen offset:32
    buffer_load_dwordx2 v[34:35], v4, s[12:15], s6 offen offset:48
    s_mov_b32 s6, 98304
    v_lshrrev_b32 v6, 5, v0
    v_lshlrev_b32 v6, 2, v6
    v_bfe_u32 v7, v0, 2, 2
    v_add_u32 v6, v6, v7
    v_lshlrev_b32 v2, 7, v6
    v_bfe_u32 v6, v0, 3, 1
    v_lshl_add_u32 v2, v6, 6, v2
    v_bfe_u32 v6, v0, 4, 1
    v_lshl_add_u32 v2, v6, 5, v2
    v_and_b32 v6, 3, v0
    v_lshl_add_u32 v2, v6, 3, v2
    v_add_u32 v2, s6, v2
    v_xor_b32 v3, 64, v2
    s_lshl_b32 s6, s57, 6
    v_xor_b32 v2, s6, v2
    ds_read_b64_tr_b16 v[36:37], v2 offset:0
    ds_read_b64_tr_b16 v[38:39], v2 offset:1024
    ds_read_b64_tr_b16 v[40:41], v2 offset:2048
    ds_read_b64_tr_b16 v[42:43], v2 offset:3072
    ds_read_b64_tr_b16 v[44:45], v2 offset:3584
    ds_read_b64_tr_b16 v[46:47], v2 offset:4608
    ds_read_b64_tr_b16 v[48:49], v2 offset:5632
    ds_read_b64_tr_b16 v[50:51], v2 offset:6656
    ds_read_b64_tr_b16 v[52:53], v2 offset:7168
    ds_read_b64_tr_b16 v[54:55], v2 offset:8192
    ds_read_b64_tr_b16 v[56:57], v2 offset:9216
    ds_read_b64_tr_b16 v[58:59], v2 offset:10240
    s_waitcnt lgkmcnt(0)
    ds_read_b64_tr_b16 v[60:61], v2 offset:10752
    ds_read_b64_tr_b16 v[62:63], v2 offset:11776
    ds_read_b64_tr_b16 v[64:65], v2 offset:12800
    ds_read_b64_tr_b16 v[66:67], v2 offset:13824
    ds_read_b64_tr_b16 v[68:69], v2 offset:14336
    ds_read_b64_tr_b16 v[70:71], v2 offset:15360
    ds_read_b64_tr_b16 v[72:73], v2 offset:16384
    ds_read_b64_tr_b16 v[74:75], v2 offset:17408
    ds_read_b64_tr_b16 v[76:77], v2 offset:17920
    ds_read_b64_tr_b16 v[78:79], v2 offset:18944
    ds_read_b64_tr_b16 v[80:81], v2 offset:19968
    ds_read_b64_tr_b16 v[82:83], v2 offset:20992
    s_waitcnt lgkmcnt(0)
    ds_read_b64_tr_b16 v[84:85], v2 offset:21504
    ds_read_b64_tr_b16 v[86:87], v2 offset:22528
    ds_read_b64_tr_b16 v[88:89], v2 offset:23552
    ds_read_b64_tr_b16 v[90:91], v2 offset:24576
    ds_read_b64_tr_b16 v[92:93], v2 offset:25088
    ds_read_b64_tr_b16 v[94:95], v2 offset:26112
    ds_read_b64_tr_b16 v[96:97], v2 offset:27136
    ds_read_b64_tr_b16 v[98:99], v2 offset:28160
    ds_read_b64_tr_b16 v[100:101], v2 offset:28672
    ds_read_b64_tr_b16 v[102:103], v2 offset:29696
    ds_read_b64_tr_b16 v[104:105], v2 offset:30720
    ds_read_b64_tr_b16 v[106:107], v2 offset:31744
    s_waitcnt lgkmcnt(0)
    ds_read_b64_tr_b16 v[108:109], v2 offset:32256
    ds_read_b64_tr_b16 v[110:111], v2 offset:33280
    ds_read_b64_tr_b16 v[112:113], v2 offset:34304
    ds_read_b64_tr_b16 v[114:115], v2 offset:35328
    ds_read_b64_tr_b16 v[116:117], v2 offset:35840
    ds_read_b64_tr_b16 v[118:119], v2 offset:36864
    ds_read_b64_tr_b16 v[120:121], v2 offset:37888
    ds_read_b64_tr_b16 v[122:123], v2 offset:38912
    ds_read_b64_tr_b16 v[124:125], v2 offset:39424
    ds_read_b64_tr_b16 v[126:127], v2 offset:40448
    ds_read_b64_tr_b16 v[128:129], v2 offset:41472
    ds_read_b64_tr_b16 v[130:131], v2 offset:42496
    s_waitcnt lgkmcnt(0)
    ds_read_b64_tr_b16 v[132:133], v2 offset:43008
    ds_read_b64_tr_b16 v[134:135], v2 offset:44032
    ds_read_b64_tr_b16 v[136:137], v2 offset:45056
    ds_read_b64_tr_b16 v[138:139], v2 offset:46080
    ds_read_b64_tr_b16 v[140:141], v2 offset:46592
    ds_read_b64_tr_b16 v[142:143], v2 offset:47616
    ds_read_b64_tr_b16 v[144:145], v2 offset:48640
    ds_read_b64_tr_b16 v[146:147], v2 offset:49664
    ds_read_b64_tr_b16 v[148:149], v2 offset:50176
    ds_read_b64_tr_b16 v[150:151], v2 offset:51200
    ds_read_b64_tr_b16 v[152:153], v2 offset:52224
    ds_read_b64_tr_b16 v[154:155], v2 offset:53248
    s_waitcnt lgkmcnt(0)
    ds_read_b64_tr_b16 v[156:157], v2 offset:53760
    ds_read_b64_tr_b16 v[158:159], v2 offset:54784
    ds_read_b64_tr_b16 v[160:161], v2 offset:55808
    ds_read_b64_tr_b16 v[162:163], v2 offset:56832
    s_add_u32 s16, s54, 0x800000
    s_addc_u32 s17, s55, 0
    s_mov_b32 s18, 0x800
    s_mov_b32 s19, 0x20000
    s_and_b32 s6, s64, 31
    s_mul_i32 s6, s6, 65536
    s_add_u32 s16, s16, s6
    s_addc_u32 s17, s17, 0
    s_add_u32 s7, s54, 0x800000
    s_add_u32 s7, s7, s6
    s_lshr_b32 s7, s7, 19
    s_xor_b32 s7, s7, s4
    s_xor_b32 s7, s7, s88
    s_and_b32 s7, s7, 4
    s_lshl_b32 s7, s7, 11
    s_add_u32 s16, s16, s7
    s_addc_u32 s17, s17, 0
    s_lshl_b32 s6, s65, 1
    s_lshr_b32 s7, s6, 3
    s_lshl_b32 s7, s7, 3
    s_add_u32 s6, s6, s7
    s_lshl_b32 s6, s6, 10
    s_add_u32 s16, s16, s6
    s_addc_u32 s17, s17, 0
    s_add_u32 s20, s54, 0xa00000
    s_addc_u32 s21, s55, 0
    s_mov_b32 s22, 0x100
    s_mov_b32 s23, 0x20000
    s_and_b32 s6, s64, 31
    s_and_b32 s7, s6, 1
    s_lshl_b32 s7, s7, 12
    s_lshr_b32 s6, s6, 1
    s_lshl_b32 s6, s6, 14
    s_add_u32 s6, s6, s7
    s_add_u32 s20, s20, s6
    s_addc_u32 s21, s21, 0
    s_add_u32 s7, s54, 0xa00000
    s_add_u32 s7, s7, s6
    s_lshr_b32 s7, s7, 19
    s_xor_b32 s7, s7, s4
    s_xor_b32 s7, s7, s88
    s_and_b32 s7, s7, 4
    s_lshl_b32 s7, s7, 11
    s_add_u32 s20, s20, s7
    s_addc_u32 s21, s21, 0
    s_lshl_b32 s6, s65, 8
    s_add_u32 s20, s20, s6
    s_addc_u32 s21, s21, 0
    s_lshl_b32 s6, s56, 15
    s_add_u32 s6, s6, 32768
    v_add_u32 v5, s6, v1
    v_lshlrev_b32 v4, 3, v0
    v_and_b32 v3, 15, v0
    v_lshlrev_b32 v3, 4, v3
    v_bfe_u32 v6, v0, 4, 1
    v_lshl_add_u32 v3, v6, 10, v3
    v_lshrrev_b32 v6, 5, v0
    v_lshl_add_u32 v3, v6, 8, v3
    s_mov_b32 s67, 0x3f803f80
    s_waitcnt vmcnt(0)
    v_lshlrev_b32 v12, 16, v28
    v_and_b32 v13, 0xffff0000, v28
    v_lshlrev_b32 v14, 16, v29
    v_and_b32 v15, 0xffff0000, v29
    v_lshlrev_b32 v16, 16, v30
    v_and_b32 v17, 0xffff0000, v30
    v_lshlrev_b32 v18, 16, v31
    v_and_b32 v19, 0xffff0000, v31
    v_lshlrev_b32 v20, 16, v32
    v_and_b32 v21, 0xffff0000, v32
    v_lshlrev_b32 v22, 16, v33
    v_and_b32 v23, 0xffff0000, v33
    v_lshlrev_b32 v24, 16, v34
    v_and_b32 v25, 0xffff0000, v34
    v_lshlrev_b32 v26, 16, v35
    v_and_b32 v27, 0xffff0000, v35
    v_mov_b32 v6, 0
    v_mov_b32 v7, 0
    s_waitcnt lgkmcnt(0)
    s_barrier
    s_barrier
    ds_read_b128 v[28:31], v5 offset:0
    ds_read_b128 v[32:35], v5 offset:1024
    s_waitcnt lgkmcnt(1)
    v_mfma_f32_32x32x16_bf16 v[12:27], v[36:39], v[28:31], v[12:27]
    ds_read_b128 v[8:11], v5 offset:2048
    s_waitcnt lgkmcnt(1)
    v_mfma_f32_32x32x16_bf16 v[12:27], v[40:43], v[32:35], v[12:27]
    ds_read_b128 v[28:31], v5 offset:3072
    s_waitcnt lgkmcnt(1)
    v_mfma_f32_32x32x16_bf16 v[12:27], v[44:47], v[8:11], v[12:27]
    ds_read_b128 v[32:35], v5 offset:4096
    s_waitcnt lgkmcnt(1)
    v_mfma_f32_32x32x16_bf16 v[12:27], v[48:51], v[28:31], v[12:27]
    ds_read_b128 v[8:11], v5 offset:5120
    s_waitcnt lgkmcnt(1)
    v_mfma_f32_32x32x16_bf16 v[12:27], v[52:55], v[32:35], v[12:27]
    ds_read_b128 v[28:31], v5 offset:6144
    s_waitcnt lgkmcnt(1)
    v_mfma_f32_32x32x16_bf16 v[12:27], v[56:59], v[8:11], v[12:27]
    ds_read_b128 v[32:35], v5 offset:7168
    s_waitcnt lgkmcnt(1)
    v_mfma_f32_32x32x16_bf16 v[12:27], v[60:63], v[28:31], v[12:27]
    s_barrier
    ds_read_b128 v[8:11], v5 offset:8192
    s_waitcnt lgkmcnt(1)
    v_mfma_f32_32x32x16_bf16 v[12:27], v[64:67], v[32:35], v[12:27]
    ds_read_b128 v[28:31], v5 offset:9216
    s_waitcnt lgkmcnt(1)
    v_mfma_f32_32x32x16_bf16 v[12:27], v[68:71], v[8:11], v[12:27]
    ds_read_b128 v[32:35], v5 offset:10240
    s_waitcnt lgkmcnt(1)
    v_mfma_f32_32x32x16_bf16 v[12:27], v[72:75], v[28:31], v[12:27]
    ds_read_b128 v[8:11], v5 offset:11264
    s_waitcnt lgkmcnt(1)
    v_mfma_f32_32x32x16_bf16 v[12:27], v[76:79], v[32:35], v[12:27]
    ds_read_b128 v[28:31], v5 offset:12288
    s_waitcnt lgkmcnt(1)
    v_mfma_f32_32x32x16_bf16 v[12:27], v[80:83], v[8:11], v[12:27]
    ds_read_b128 v[32:35], v5 offset:13312
    s_waitcnt lgkmcnt(1)
    v_mfma_f32_32x32x16_bf16 v[12:27], v[84:87], v[28:31], v[12:27]
    ds_read_b128 v[8:11], v5 offset:14336
    s_waitcnt lgkmcnt(1)
    v_mfma_f32_32x32x16_bf16 v[12:27], v[88:91], v[32:35], v[12:27]
    ds_read_b128 v[28:31], v5 offset:15360
    s_waitcnt lgkmcnt(1)
    v_mfma_f32_32x32x16_bf16 v[12:27], v[92:95], v[8:11], v[12:27]
    s_barrier
    ds_read_b128 v[32:35], v5 offset:16384
    s_waitcnt lgkmcnt(1)
    v_mfma_f32_32x32x16_bf16 v[12:27], v[96:99], v[28:31], v[12:27]
    ds_read_b128 v[8:11], v5 offset:17408
    s_waitcnt lgkmcnt(1)
    v_mfma_f32_32x32x16_bf16 v[12:27], v[100:103], v[32:35], v[12:27]
    ds_read_b128 v[28:31], v5 offset:18432
    s_waitcnt lgkmcnt(1)
    v_mfma_f32_32x32x16_bf16 v[12:27], v[104:107], v[8:11], v[12:27]
    ds_read_b128 v[32:35], v5 offset:19456
    s_waitcnt lgkmcnt(1)
    v_mfma_f32_32x32x16_bf16 v[12:27], v[108:111], v[28:31], v[12:27]
    ds_read_b128 v[8:11], v5 offset:20480
    s_waitcnt lgkmcnt(1)
    v_mfma_f32_32x32x16_bf16 v[12:27], v[112:115], v[32:35], v[12:27]
    ds_read_b128 v[28:31], v5 offset:21504
    s_waitcnt lgkmcnt(1)
    v_mfma_f32_32x32x16_bf16 v[12:27], v[116:119], v[8:11], v[12:27]
    ds_read_b128 v[32:35], v5 offset:22528
    s_waitcnt lgkmcnt(1)
    v_mfma_f32_32x32x16_bf16 v[12:27], v[120:123], v[28:31], v[12:27]
    ds_read_b128 v[8:11], v5 offset:23552
    s_waitcnt lgkmcnt(1)
    v_mfma_f32_32x32x16_bf16 v[12:27], v[124:127], v[32:35], v[12:27]
    s_barrier
    ds_read_b128 v[28:31], v5 offset:24576
    s_waitcnt lgkmcnt(1)
    v_mfma_f32_32x32x16_bf16 v[12:27], v[128:131], v[8:11], v[12:27]
    ds_read_b128 v[32:35], v5 offset:25600
    s_waitcnt lgkmcnt(1)
    v_mfma_f32_32x32x16_bf16 v[12:27], v[132:135], v[28:31], v[12:27]
    ds_read_b128 v[8:11], v5 offset:26624
    s_waitcnt lgkmcnt(1)
    v_mfma_f32_32x32x16_bf16 v[12:27], v[136:139], v[32:35], v[12:27]
    ds_read_b128 v[28:31], v5 offset:27648
    s_waitcnt lgkmcnt(1)
    v_mfma_f32_32x32x16_bf16 v[12:27], v[140:143], v[8:11], v[12:27]
    ds_read_b128 v[32:35], v5 offset:28672
    s_waitcnt lgkmcnt(1)
    v_mfma_f32_32x32x16_bf16 v[12:27], v[144:147], v[28:31], v[12:27]
    ds_read_b128 v[8:11], v5 offset:29696
    s_waitcnt lgkmcnt(1)
    v_mfma_f32_32x32x16_bf16 v[12:27], v[148:151], v[32:35], v[12:27]
    ds_read_b128 v[28:31], v5 offset:30720
    s_waitcnt lgkmcnt(1)
    v_mfma_f32_32x32x16_bf16 v[12:27], v[152:155], v[8:11], v[12:27]
    ds_read_b128 v[32:35], v5 offset:31744
    s_waitcnt lgkmcnt(1)
    v_mfma_f32_32x32x16_bf16 v[12:27], v[156:159], v[28:31], v[12:27]
    s_waitcnt lgkmcnt(0)
    v_mfma_f32_32x32x16_bf16 v[12:27], v[160:163], v[32:35], v[12:27]
    s_nop 11
    v_cvt_pk_bf16_f32 v28, v12, v13
    v_cvt_pk_bf16_f32 v29, v14, v15
    v_cvt_pk_bf16_f32 v30, v16, v17
    v_cvt_pk_bf16_f32 v31, v18, v19
    v_cvt_pk_bf16_f32 v32, v20, v21
    v_cvt_pk_bf16_f32 v33, v22, v23
    v_cvt_pk_bf16_f32 v34, v24, v25
    v_cvt_pk_bf16_f32 v35, v26, v27
    buffer_store_dwordx4 v[28:31], v3, s[16:19], 0 offen sc1
    buffer_store_dwordx4 v[32:35], v3, s[16:19], 0 offen offset:512 sc1
    v_dot2c_f32_bf16 v6, s67, v28
    v_dot2c_f32_bf16 v7, v28, v28
    v_dot2c_f32_bf16 v6, s67, v29
    v_dot2c_f32_bf16 v7, v29, v29
    v_dot2c_f32_bf16 v6, s67, v30
    v_dot2c_f32_bf16 v7, v30, v30
    v_dot2c_f32_bf16 v6, s67, v31
    v_dot2c_f32_bf16 v7, v31, v31
    v_dot2c_f32_bf16 v6, s67, v32
    v_dot2c_f32_bf16 v7, v32, v32
    v_dot2c_f32_bf16 v6, s67, v33
    v_dot2c_f32_bf16 v7, v33, v33
    v_dot2c_f32_bf16 v6, s67, v34
    v_dot2c_f32_bf16 v7, v34, v34
    v_dot2c_f32_bf16 v6, s67, v35
    v_dot2c_f32_bf16 v7, v35, v35
    s_nop 1
    v_mov_b32 v8, v6
    v_mov_b32 v9, v7
    s_nop 0
    v_permlane32_swap_b32 v8, v6
    v_permlane32_swap_b32 v9, v7
    v_pk_add_f32 v[6:7], v[6:7], v[8:9]
    buffer_store_dwordx2 v[6:7], v4, s[20:23], 0 offen sc1
    s_waitcnt vmcnt(0) lgkmcnt(0)
    s_barrier
    s_branch p3_done
p3_idle:
    s_barrier
    s_barrier
    s_barrier
    s_barrier
    s_barrier
    s_barrier
    s_branch p3_done
colsum:
    s_and_b32 s6, s4, 3
    s_lshl_b32 s6, s6, 2
    s_add_u32 s6, s6, s5
    s_sub_u32 s6, s6, 28
    s_cmp_ge_u32 s4, 4
    s_cselect_b32 s8, s46, s44
    s_cselect_b32 s9, s47, s45
    s_cselect_b32 s32, 7168, 0
    s_mov_b32 s10, 1605632
    s_mov_b32 s11, 0x20000
    s_mul_i32 s7, s6, 448
    s_add_u32 s32, s32, s7
    s_mul_i32 s7, s6, 224
    s_mul_i32 s6, s3, 14336
    s_add_u32 s7, s7, s6
    v_mul_u32_u24 v5, 37450, v0
    v_lshrrev_b32 v5, 19, v5
    v_mul_u32_u24 v3, 14, v5
    v_sub_u32 v3, v0, v3
    v_mul_u32_u24 v2, 3584, v5
    v_lshl_add_u32 v2, v3, 4, v2
    v_cmp_gt_u32 vcc, 56, v0
    v_mov_b32 v6, 0x40000000
    s_nop 0
    v_cndmask_b32 v2, v6, v2, vcc
    buffer_load_dwordx4 v[16:19], v2, s[8:11], s7 offen
    s_add_u32 s7, s7, 114688
    buffer_load_dwordx4 v[20:23], v2, s[8:11], s7 offen
    s_add_u32 s7, s7, 114688
    buffer_load_dwordx4 v[24:27], v2, s[8:11], s7 offen
    s_add_u32 s7, s7, 114688
    buffer_load_dwordx4 v[28:31], v2, s[8:11], s7 offen
    s_add_u32 s7, s7, 114688
    buffer_load_dwordx4 v[32:35], v2, s[8:11], s7 offen
    s_add_u32 s7, s7, 114688
    buffer_load_dwordx4 v[36:39], v2, s[8:11], s7 offen
    s_add_u32 s7, s7, 114688
    buffer_load_dwordx4 v[40:43], v2, s[8:11], s7 offen
    s_add_u32 s7, s7, 114688
    buffer_load_dwordx4 v[44:47], v2, s[8:11], s7 offen
    s_add_u32 s7, s7, 114688
    buffer_load_dwordx4 v[48:51], v2, s[8:11], s7 offen
    s_add_u32 s7, s7, 114688
    buffer_load_dwordx4 v[52:55], v2, s[8:11], s7 offen
    s_add_u32 s7, s7, 114688
    buffer_load_dwordx4 v[56:59], v2, s[8:11], s7 offen
    s_add_u32 s7, s7, 114688
    buffer_load_dwordx4 v[60:63], v2, s[8:11], s7 offen
    s_add_u32 s7, s7, 114688
    buffer_load_dwordx4 v[64:67], v2, s[8:11], s7 offen
    s_add_u32 s7, s7, 114688
    buffer_load_dwordx4 v[68:71], v2, s[8:11], s7 offen
    s_add_u32 s12, s54, 0xa80000
    s_addc_u32 s13, s55, 0
    s_mov_b32 s14, 0x3800
    s_mov_b32 s15, 0x20000
    v_mov_b32 v8, 0
    v_mov_b32 v9, 0
    v_mov_b32 v10, 0
    v_mov_b32 v11, 0
    v_mov_b32 v12, 0
    v_mov_b32 v13, 0
    v_mov_b32 v14, 0
    v_mov_b32 v15, 0
    s_waitcnt vmcnt(13)
    v_lshlrev_b32 v80, 16, v16
    v_and_b32 v81, 0xffff0000, v16
    v_lshlrev_b32 v82, 16, v17
    v_and_b32 v83, 0xffff0000, v17
    v_lshlrev_b32 v84, 16, v18
    v_and_b32 v85, 0xffff0000, v18
    v_lshlrev_b32 v86, 16, v19
    v_and_b32 v87, 0xffff0000, v19
    v_pk_add_f32 v[8:9], v[8:9], v[80:81]
    v_pk_add_f32 v[10:11], v[10:11], v[82:83]
    v_pk_add_f32 v[12:13], v[12:13], v[84:85]
    v_pk_add_f32 v[14:15], v[14:15], v[86:87]
    s_waitcnt vmcnt(12)
    v_lshlrev_b32 v80, 16, v20
    v_and_b32 v81, 0xffff0000, v20
    v_lshlrev_b32 v82, 16, v21
    v_and_b32 v83, 0xffff0000, v21
    v_lshlrev_b32 v84, 16, v22
    v_and_b32 v85, 0xffff0000, v22
    v_lshlrev_b32 v86, 16, v23
    v_and_b32 v87, 0xffff0000, v23
    v_pk_add_f32 v[8:9], v[8:9], v[80:81]
    v_pk_add_f32 v[10:11], v[10:11], v[82:83]
    v_pk_add_f32 v[12:13], v[12:13], v[84:85]
    v_pk_add_f32 v[14:15], v[14:15], v[86:87]
    s_waitcnt vmcnt(11)
    v_lshlrev_b32 v80, 16, v24
    v_and_b32 v81, 0xffff0000, v24
    v_lshlrev_b32 v82, 16, v25
    v_and_b32 v83, 0xffff0000, v25
    v_lshlrev_b32 v84, 16, v26
    v_and_b32 v85, 0xffff0000, v26
    v_lshlrev_b32 v86, 16, v27
    v_and_b32 v87, 0xffff0000, v27
    v_pk_add_f32 v[8:9], v[8:9], v[80:81]
    v_pk_add_f32 v[10:11], v[10:11], v[82:83]
    v_pk_add_f32 v[12:13], v[12:13], v[84:85]
    v_pk_add_f32 v[14:15], v[14:15], v[86:87]
    s_waitcnt vmcnt(10)
    v_lshlrev_b32 v80, 16, v28
    v_and_b32 v81, 0xffff0000, v28
    v_lshlrev_b32 v82, 16, v29
    v_and_b32 v83, 0xffff0000, v29
    v_lshlrev_b32 v84, 16, v30
    v_and_b32 v85, 0xffff0000, v30
    v_lshlrev_b32 v86, 16, v31
    v_and_b32 v87, 0xffff0000, v31
    v_pk_add_f32 v[8:9], v[8:9], v[80:81]
    v_pk_add_f32 v[10:11], v[10:11], v[82:83]
    v_pk_add_f32 v[12:13], v[12:13], v[84:85]
    v_pk_add_f32 v[14:15], v[14:15], v[86:87]
    s_waitcnt vmcnt(9)
    v_lshlrev_b32 v80, 16, v32
    v_and_b32 v81, 0xffff0000, v32
    v_lshlrev_b32 v82, 16, v33
    v_and_b32 v83, 0xffff0000, v33
    v_lshlrev_b32 v84, 16, v34
    v_and_b32 v85, 0xffff0000, v34
    v_lshlrev_b32 v86, 16, v35
    v_and_b32 v87, 0xffff0000, v35
    v_pk_add_f32 v[8:9], v[8:9], v[80:81]
    v_pk_add_f32 v[10:11], v[10:11], v[82:83]
    v_pk_add_f32 v[12:13], v[12:13], v[84:85]
    v_pk_add_f32 v[14:15], v[14:15], v[86:87]
    s_waitcnt vmcnt(8)
    v_lshlrev_b32 v80, 16, v36
    v_and_b32 v81, 0xffff0000, v36
    v_lshlrev_b32 v82, 16, v37
    v_and_b32 v83, 0xffff0000, v37
    v_lshlrev_b32 v84, 16, v38
    v_and_b32 v85, 0xffff0000, v38
    v_lshlrev_b32 v86, 16, v39
    v_and_b32 v87, 0xffff0000, v39
    v_pk_add_f32 v[8:9], v[8:9], v[80:81]
    v_pk_add_f32 v[10:11], v[10:11], v[82:83]
    v_pk_add_f32 v[12:13], v[12:13], v[84:85]
    v_pk_add_f32 v[14:15], v[14:15], v[86:87]
    s_waitcnt vmcnt(7)
    v_lshlrev_b32 v80, 16, v40
    v_and_b32 v81, 0xffff0000, v40
    v_lshlrev_b32 v82, 16, v41
    v_and_b32 v83, 0xffff0000, v41
    v_lshlrev_b32 v84, 16, v42
    v_and_b32 v85, 0xffff0000, v42
    v_lshlrev_b32 v86, 16, v43
    v_and_b32 v87, 0xffff0000, v43
    v_pk_add_f32 v[8:9], v[8:9], v[80:81]
    v_pk_add_f32 v[10:11], v[10:11], v[82:83]
    v_pk_add_f32 v[12:13], v[12:13], v[84:85]
    v_pk_add_f32 v[14:15], v[14:15], v[86:87]
    s_waitcnt vmcnt(6)
    v_lshlrev_b32 v80, 16, v44
    v_and_b32 v81, 0xffff0000, v44
    v_lshlrev_b32 v82, 16, v45
    v_and_b32 v83, 0xffff0000, v45
    v_lshlrev_b32 v84, 16, v46
    v_and_b32 v85, 0xffff0000, v46
    v_lshlrev_b32 v86, 16, v47
    v_and_b32 v87, 0xffff0000, v47
    v_pk_add_f32 v[8:9], v[8:9], v[80:81]
    v_pk_add_f32 v[10:11], v[10:11], v[82:83]
    v_pk_add_f32 v[12:13], v[12:13], v[84:85]
    v_pk_add_f32 v[14:15], v[14:15], v[86:87]
    s_waitcnt vmcnt(5)
    v_lshlrev_b32 v80, 16, v48
    v_and_b32 v81, 0xffff0000, v48
    v_lshlrev_b32 v82, 16, v49
    v_and_b32 v83, 0xffff0000, v49
    v_lshlrev_b32 v84, 16, v50
    v_and_b32 v85, 0xffff0000, v50
    v_lshlrev_b32 v86, 16, v51
    v_and_b32 v87, 0xffff0000, v51
    v_pk_add_f32 v[8:9], v[8:9], v[80:81]
    v_pk_add_f32 v[10:11], v[10:11], v[82:83]
    v_pk_add_f32 v[12:13], v[12:13], v[84:85]
    v_pk_add_f32 v[14:15], v[14:15], v[86:87]
    s_waitcnt vmcnt(4)
    v_lshlrev_b32 v80, 16, v52
    v_and_b32 v81, 0xffff0000, v52
    v_lshlrev_b32 v82, 16, v53
    v_and_b32 v83, 0xffff0000, v53
    v_lshlrev_b32 v84, 16, v54
    v_and_b32 v85, 0xffff0000, v54
    v_lshlrev_b32 v86, 16, v55
    v_and_b32 v87, 0xffff0000, v55
    v_pk_add_f32 v[8:9], v[8:9], v[80:81]
    v_pk_add_f32 v[10:11], v[10:11], v[82:83]
    v_pk_add_f32 v[12:13], v[12:13], v[84:85]
    v_pk_add_f32 v[14:15], v[14:15], v[86:87]
    s_waitcnt vmcnt(3)
    v_lshlrev_b32 v80, 16, v56
    v_and_b32 v81, 0xffff0000, v56
    v_lshlrev_b32 v82, 16, v57
    v_and_b32 v83, 0xffff0000, v57
    v_lshlrev_b32 v84, 16, v58
    v_and_b32 v85, 0xffff0000, v58
    v_lshlrev_b32 v86, 16, v59
    v_and_b32 v87, 0xffff0000, v59
    v_pk_add_f32 v[8:9], v[8:9], v[80:81]
    v_pk_add_f32 v[10:11], v[10:11], v[82:83]
    v_pk_add_f32 v[12:13], v[12:13], v[84:85]
    v_pk_add_f32 v[14:15], v[14:15], v[86:87]
    s_waitcnt vmcnt(2)
    v_lshlrev_b32 v80, 16, v60
    v_and_b32 v81, 0xffff0000, v60
    v_lshlrev_b32 v82, 16, v61
    v_and_b32 v83, 0xffff0000, v61
    v_lshlrev_b32 v84, 16, v62
    v_and_b32 v85, 0xffff0000, v62
    v_lshlrev_b32 v86, 16, v63
    v_and_b32 v87, 0xffff0000, v63
    v_pk_add_f32 v[8:9], v[8:9], v[80:81]
    v_pk_add_f32 v[10:11], v[10:11], v[82:83]
    v_pk_add_f32 v[12:13], v[12:13], v[84:85]
    v_pk_add_f32 v[14:15], v[14:15], v[86:87]
    s_waitcnt vmcnt(1)
    v_lshlrev_b32 v80, 16, v64
    v_and_b32 v81, 0xffff0000, v64
    v_lshlrev_b32 v82, 16, v65
    v_and_b32 v83, 0xffff0000, v65
    v_lshlrev_b32 v84, 16, v66
    v_and_b32 v85, 0xffff0000, v66
    v_lshlrev_b32 v86, 16, v67
    v_and_b32 v87, 0xffff0000, v67
    v_pk_add_f32 v[8:9], v[8:9], v[80:81]
    v_pk_add_f32 v[10:11], v[10:11], v[82:83]
    v_pk_add_f32 v[12:13], v[12:13], v[84:85]
    v_pk_add_f32 v[14:15], v[14:15], v[86:87]
    s_waitcnt vmcnt(0)
    v_lshlrev_b32 v80, 16, v68
    v_and_b32 v81, 0xffff0000, v68
    v_lshlrev_b32 v82, 16, v69
    v_and_b32 v83, 0xffff0000, v69
    v_lshlrev_b32 v84, 16, v70
    v_and_b32 v85, 0xffff0000, v70
    v_lshlrev_b32 v86, 16, v71
    v_and_b32 v87, 0xffff0000, v71
    v_pk_add_f32 v[8:9], v[8:9], v[80:81]
    v_pk_add_f32 v[10:11], v[10:11], v[82:83]
    v_pk_add_f32 v[12:13], v[12:13], v[84:85]
    v_pk_add_f32 v[14:15], v[14:15], v[86:87]
    s_lshl_b32 s6, s3, 11
    v_lshlrev_b32 v4, 9, v5
    v_lshl_add_u32 v4, v3, 5, v4
    v_add_u32 v4, s6, v4
    s_mov_b32 exec_hi, 0xffffff
    ds_write_b128 v4, v[8:11]
    ds_write_b128 v4, v[12:15] offset:16
    s_mov_b32 exec_hi, -1
    s_waitcnt lgkmcnt(0)
    s_barrier
    s_cmp_ge_u32 s3, 2
    s_cbranch_scc1 colsum_ns
    s_lshl_b32 s6, s3, 8
    v_lshl_add_u32 v4, v0, 2, s6
    ds_read_b32 v16, v4 offset:0
    ds_read_b32 v17, v4 offset:512
    ds_read_b32 v18, v4 offset:1024
    ds_read_b32 v19, v4 offset:1536
    ds_read_b32 v20, v4 offset:2048
    ds_read_b32 v21, v4 offset:2560
    ds_read_b32 v22, v4 offset:3072
    ds_read_b32 v23, v4 offset:3584
    ds_read_b32 v24, v4 offset:4096
    ds_read_b32 v25, v4 offset:4608
    ds_read_b32 v26, v4 offset:5120
    ds_read_b32 v27, v4 offset:5632
    ds_read_b32 v28, v4 offset:6144
    ds_read_b32 v29, v4 offset:6656
    ds_read_b32 v30, v4 offset:7168
    s_waitcnt lgkmcnt(0)
    ds_read_b32 v31, v4 offset:7680
    ds_read_b32 v32, v4 offset:8192
    ds_read_b32 v33, v4 offset:8704
    ds_read_b32 v34, v4 offset:9216
    ds_read_b32 v35, v4 offset:9728
    ds_read_b32 v36, v4 offset:10240
    ds_read_b32 v37, v4 offset:10752
    ds_read_b32 v38, v4 offset:11264
    ds_read_b32 v39, v4 offset:11776
    ds_read_b32 v40, v4 offset:12288
    ds_read_b32 v41, v4 offset:12800
    ds_read_b32 v42, v4 offset:13312
    ds_read_b32 v43, v4 offset:13824
    ds_read_b32 v44, v4 offset:14336
    ds_read_b32 v45, v4 offset:14848
    s_waitcnt lgkmcnt(0)
    ds_read_b32 v46, v4 offset:15360
    ds_read_b32 v47, v4 offset:15872
    s_waitcnt lgkmcnt(0)
    v_pk_add_f32 v[16:17], v[16:17], v[32:33]
    v_pk_add_f32 v[18:19], v[18:19], v[34:35]
    v_pk_add_f32 v[20:21], v[20:21], v[36:37]
    v_pk_add_f32 v[22:23], v[22:23], v[38:39]
    v_pk_add_f32 v[24:25], v[24:25], v[40:41]
    v_pk_add_f32 v[26:27], v[26:27], v[42:43]
    v_pk_add_f32 v[28:29], v[28:29], v[44:45]
    v_pk_add_f32 v[30:31], v[30:31], v[46:47]
    v_pk_add_f32 v[16:17], v[16:17], v[24:25]
    v_pk_add_f32 v[18:19], v[18:19], v[26:27]
    v_pk_add_f32 v[20:21], v[20:21], v[28:29]
    v_pk_add_f32 v[22:23], v[22:23], v[30:31]
    v_pk_add_f32 v[16:17], v[16:17], v[20:21]
    v_pk_add_f32 v[18:19], v[18:19], v[22:23]
    v_pk_add_f32 v[16:17], v[16:17], v[18:19]
    v_add_f32 v16, v16, v17
    v_cmp_gt_u32 vcc, 448, v4
    s_nop 0
    s_and_b64 exec, exec, vcc
    buffer_store_dword v16, v4, s[12:15], s32 offen sc1
    s_mov_b64 exec, -1
colsum_ns:
    s_waitcnt vmcnt(0) lgkmcnt(0)
    s_barrier
p3_done:
    s_and_b32 s6, s4, 3
    s_lshl_b32 s6, s6, 2
    s_and_b32 s7, s5, 3
    s_add_u32 s32, s6, s7
    s_lshr_b32 s6, s4, 2
    s_lshl_b32 s6, s6, 3
    s_lshr_b32 s7, s5, 2
    s_add_u32 s33, s6, s7
    s_lshr_b32 s34, s3, 2
    s_lshl_b32 s35, s33, 2
    s_add_u32 s35, s35, s58
    v_lshrrev_b32 v7, 4, v0
    s_lshl_b32 s6, s34, 9
    s_add_u32 s6, s6, 94336
    v_lshl_add_u32 v4, v7, 4, s6
    v_lshrrev_b32 v6, 5, v0
    v_lshlrev_b32 v2, 4, v6
    v_lshlrev_b32 v162, 8, v6
    v_bfe_u32 v6, v0, 4, 1
    v_lshl_add_u32 v2, v6, 2, v2
    v_lshl_add_u32 v162, v6, 9, v162
    v_bfe_u32 v6, v0, 2, 2
    v_add_u32 v2, v2, v6
    v_mul_u32_u24 v2, 224, v2
    v_and_b32 v6, 3, v0
    v_lshl_add_u32 v2, v6, 3, v2
    s_lshl_b32 s6, s34, 7
    s_add_u32 s6, s6, 0
    v_add_u32 v2, s6, v2
    s_lshl_b32 s6, s58, 12
    s_add_u32 s6, s6, 131072
    v_add_u32 v3, s6, v1
    v_and_b32 v6, 15, v0
    v_lshl_add_u32 v162, v6, 4, v162
    s_lshl_b32 s6, s58, 9
    s_add_u32 s6, s6, 95232
    v_lshl_add_u32 v5, v6, 4, s6
    s_add_u32 s12, s54, 0xc00000
    s_addc_u32 s13, s55, 0
    s_mov_b32 s14, 0x36000
    s_mov_b32 s15, 0x20000
    s_and_b32 s6, s35, 31
    s_mul_i32 s7, s6, 57
    s_lshr_b32 s7, s7, 9
    s_mul_i32 s7, s7, 32768
    s_mul_i32 s6, s6, 229376
    s_add_u32 s6, s6, s7
    s_add_u32 s12, s12, s6
    s_addc_u32 s13, s13, 0
    s_add_u32 s7, s54, 0xc00000
    s_add_u32 s7, s7, s6
    s_lshr_b32 s7, s7, 19
    s_xor_b32 s7, s7, s4
    s_xor_b32 s7, s7, s88
    s_and_b32 s7, s7, 4
    s_lshl_b32 s7, s7, 11
    s_add_u32 s12, s12, s7
    s_addc_u32 s13, s13, 0
    s_mul_i32 s56, s32, 7
    s_lshl_b32 s6, s34, 2
    s_add_u32 s56, s56, s6
    s_lshr_b32 s7, s56, 3
    s_lshl_b32 s7, s7, 3
    s_add_u32 s68, s56, s7
    s_lshl_b32 s68, s68, 10
    s_add_u32 s56, s56, 1
    s_lshr_b32 s7, s56, 3
    s_lshl_b32 s7, s7, 3
    s_add_u32 s69, s56, s7
    s_lshl_b32 s69, s69, 10
    s_add_u32 s56, s56, 1
    s_lshr_b32 s7, s56, 3
    s_lshl_b32 s7, s7, 3
    s_add_u32 s70, s56, s7
    s_lshl_b32 s70, s70, 10
    s_add_u32 s56, s56, 1
    s_lshr_b32 s7, s56, 3
    s_lshl_b32 s7, s7, 3
    s_add_u32 s71, s56, s7
    s_lshl_b32 s71, s71, 10
    s_add_u32 s56, s56, 1
    v_mov_b32 v16, 0
    v_mov_b32 v17, 0
    v_mov_b32 v18, 0
    v_mov_b32 v19, 0
    v_mov_b32 v20, 0
    v_mov_b32 v21, 0
    v_mov_b32 v22, 0
    v_mov_b32 v23, 0
    v_mov_b32 v24, 0
    v_mov_b32 v25, 0
    v_mov_b32 v26, 0
    v_mov_b32 v27, 0
    v_mov_b32 v28, 0
    v_mov_b32 v29, 0
    v_mov_b32 v30, 0
    v_mov_b32 v31, 0
    v_mov_b32 v32, 0
    v_mov_b32 v33, 0
    v_mov_b32 v34, 0
    v_mov_b32 v35, 0
    v_mov_b32 v36, 0
    v_mov_b32 v37, 0
    v_mov_b32 v38, 0
    v_mov_b32 v39, 0
    v_mov_b32 v40, 0
    v_mov_b32 v41, 0
    v_mov_b32 v42, 0
    v_mov_b32 v43, 0
    v_mov_b32 v44, 0
    v_mov_b32 v45, 0
    v_mov_b32 v46, 0
    v_mov_b32 v47, 0
    v_mov_b32 v48, 0
    v_mov_b32 v49, 0
    v_mov_b32 v50, 0
    v_mov_b32 v51, 0
    v_mov_b32 v52, 0
    v_mov_b32 v53, 0
    v_mov_b32 v54, 0
    v_mov_b32 v55, 0
    v_mov_b32 v56, 0
    v_mov_b32 v57, 0
    v_mov_b32 v58, 0
    v_mov_b32 v59, 0
    v_mov_b32 v60, 0
    v_mov_b32 v61, 0
    v_mov_b32 v62, 0
    v_mov_b32 v63, 0
    v_mov_b32 v64, 0
    v_mov_b32 v65, 0
    v_mov_b32 v66, 0
    v_mov_b32 v67, 0
    v_mov_b32 v68, 0
    v_mov_b32 v69, 0
    v_mov_b32 v70, 0
    v_mov_b32 v71, 0
    v_mov_b32 v72, 0
    v_mov_b32 v73, 0
    v_mov_b32 v74, 0
    v_mov_b32 v75, 0
    v_mov_b32 v76, 0
    v_mov_b32 v77, 0
    v_mov_b32 v78, 0
    v_mov_b32 v79, 0
    s_barrier
    s_cmp_eq_u32 s34, 0
    s_cbranch_scc1 p4_a
    s_mov_b32 s64, 0
    s_mov_b32 s65, 0
    s_mov_b32 s66, 0
    v_mov_b32 v160, v2
    v_mov_b32 v161, v3
    s_barrier
    ds_read_b128 v[80:83], v161 offset:0
    ds_read_b128 v[84:87], v161 offset:1024
    ds_read_b64_tr_b16 v[96:97], v160 offset:0
    ds_read_b64_tr_b16 v[98:99], v160 offset:1792
    ds_read_b64_tr_b16 v[100:101], v160 offset:14464
    ds_read_b64_tr_b16 v[102:103], v160 offset:16256
    ds_read_b64_tr_b16 v[104:105], v160 offset:32
    ds_read_b64_tr_b16 v[106:107], v160 offset:1824
    ds_read_b64_tr_b16 v[108:109], v160 offset:14496
    ds_read_b64_tr_b16 v[110:111], v160 offset:16288
    ds_read_b64_tr_b16 v[112:113], v160 offset:64
    ds_read_b64_tr_b16 v[114:115], v160 offset:1856
    ds_read_b64_tr_b16 v[116:117], v160 offset:14528
    ds_read_b64_tr_b16 v[118:119], v160 offset:16320
p4_loop1:
    s_waitcnt lgkmcnt(8)
    v_mfma_f32_16x16x32_bf16 v[16:19], v[96:99], v[80:83], v[16:19]
    ds_read_b128 v[88:91], v161 offset:2048
    v_mfma_f32_16x16x32_bf16 v[20:23], v[96:99], v[84:87], v[20:23]
    ds_read_b128 v[92:95], v161 offset:3072
    ds_read_b64_tr_b16 v[128:129], v160 offset:7168
    v_mfma_f32_16x16x32_bf16 v[24:27], v[100:103], v[80:83], v[24:27]
    ds_read_b64_tr_b16 v[130:131], v160 offset:8960
    v_mfma_f32_16x16x32_bf16 v[28:31], v[100:103], v[84:87], v[28:31]
    ds_read_b64_tr_b16 v[132:133], v160 offset:21632
    ds_read_b64_tr_b16 v[134:135], v160 offset:23424
    s_waitcnt lgkmcnt(10)
    v_mfma_f32_16x16x32_bf16 v[32:35], v[104:107], v[80:83], v[32:35]
    ds_read_b64_tr_b16 v[136:137], v160 offset:7200
    v_mfma_f32_16x16x32_bf16 v[36:39], v[104:107], v[84:87], v[36:39]
    ds_read_b64_tr_b16 v[138:139], v160 offset:8992
    ds_read_b64_tr_b16 v[140:141], v160 offset:21664
    v_mfma_f32_16x16x32_bf16 v[40:43], v[108:111], v[80:83], v[40:43]
    ds_read_b64_tr_b16 v[142:143], v160 offset:23456
    v_mfma_f32_16x16x32_bf16 v[44:47], v[108:111], v[84:87], v[44:47]
    ds_read_b64_tr_b16 v[144:145], v160 offset:7232
    ds_read_b64_tr_b16 v[146:147], v160 offset:9024
    s_waitcnt lgkmcnt(12)
    v_mfma_f32_16x16x32_bf16 v[48:51], v[112:115], v[80:83], v[48:51]
    ds_read_b64_tr_b16 v[148:149], v160 offset:21696
    v_mfma_f32_16x16x32_bf16 v[52:55], v[112:115], v[84:87], v[52:55]
    ds_read_b64_tr_b16 v[150:151], v160 offset:23488
    v_mfma_f32_16x16x32_bf16 v[56:59], v[116:119], v[80:83], v[56:59]
    v_mfma_f32_16x16x32_bf16 v[60:63], v[116:119], v[84:87], v[60:63]
    s_add_u32 s65, s65, 32768
    s_and_b32 s65, s65, 0x1ffff
    s_xor_b32 s66, s66, 16384
    s_add_u32 s64, s64, 1
    s_cmp_eq_u32 s64, 5
    s_cselect_b32 s66, 0xffff8000, s66
    s_waitcnt lgkmcnt(8)
    v_mfma_f32_16x16x32_bf16 v[16:19], v[128:131], v[88:91], v[16:19]
    v_mfma_f32_16x16x32_bf16 v[20:23], v[128:131], v[92:95], v[20:23]
    v_mfma_f32_16x16x32_bf16 v[24:27], v[132:135], v[88:91], v[24:27]
    v_mfma_f32_16x16x32_bf16 v[28:31], v[132:135], v[92:95], v[28:31]
    s_waitcnt lgkmcnt(0)
    s_barrier
    v_add_u32 v160, s65, v2
    v_add_u32 v161, s66, v3
    ds_read_b128 v[80:83], v161 offset:0
    ds_read_b128 v[84:87], v161 offset:1024
    v_mfma_f32_16x16x32_bf16 v[32:35], v[136:139], v[88:91], v[32:35]
    ds_read_b64_tr_b16 v[96:97], v160 offset:0
    ds_read_b64_tr_b16 v[98:99], v160 offset:1792
    v_mfma_f32_16x16x32_bf16 v[36:39], v[136:139], v[92:95], v[36:39]
    ds_read_b64_tr_b16 v[100:101], v160 offset:14464
    ds_read_b64_tr_b16 v[102:103], v160 offset:16256
    v_mfma_f32_16x16x32_bf16 v[40:43], v[140:143], v[88:91], v[40:43]
    ds_read_b64_tr_b16 v[104:105], v160 offset:32
    ds_read_b64_tr_b16 v[106:107], v160 offset:1824
    v_mfma_f32_16x16x32_bf16 v[44:47], v[140:143], v[92:95], v[44:47]
    ds_read_b64_tr_b16 v[108:109], v160 offset:14496
    ds_read_b64_tr_b16 v[110:111], v160 offset:16288
    v_mfma_f32_16x16x32_bf16 v[48:51], v[144:147], v[88:91], v[48:51]
    ds_read_b64_tr_b16 v[112:113], v160 offset:64
    ds_read_b64_tr_b16 v[114:115], v160 offset:1856
    v_mfma_f32_16x16x32_bf16 v[52:55], v[144:147], v[92:95], v[52:55]
    ds_read_b64_tr_b16 v[116:117], v160 offset:14528
    ds_read_b64_tr_b16 v[118:119], v160 offset:16320
    v_mfma_f32_16x16x32_bf16 v[56:59], v[148:151], v[88:91], v[56:59]
    v_mfma_f32_16x16x32_bf16 v[60:63], v[148:151], v[92:95], v[60:63]
    s_cmp_lt_u32 s64, 6
    s_cbranch_scc1 p4_loop1
    s_waitcnt lgkmcnt(8)
    v_mfma_f32_16x16x32_bf16 v[16:19], v[96:99], v[80:83], v[16:19]
    ds_read_b128 v[88:91], v161 offset:2048
    v_mfma_f32_16x16x32_bf16 v[20:23], v[96:99], v[84:87], v[20:23]
    ds_read_b128 v[92:95], v161 offset:3072
    ds_read_b64_tr_b16 v[128:129], v160 offset:7168
    v_mfma_f32_16x16x32_bf16 v[24:27], v[100:103], v[80:83], v[24:27]
    ds_read_b64_tr_b16 v[130:131], v160 offset:8960
    v_mfma_f32_16x16x32_bf16 v[28:31], v[100:103], v[84:87], v[28:31]
    ds_read_b64_tr_b16 v[132:133], v160 offset:21632
    ds_read_b64_tr_b16 v[134:135], v160 offset:23424
    s_waitcnt lgkmcnt(10)
    v_mfma_f32_16x16x32_bf16 v[32:35], v[104:107], v[80:83], v[32:35]
    ds_read_b64_tr_b16 v[136:137], v160 offset:7200
    v_mfma_f32_16x16x32_bf16 v[36:39], v[104:107], v[84:87], v[36:39]
    ds_read_b64_tr_b16 v[138:139], v160 offset:8992
    ds_read_b64_tr_b16 v[140:141], v160 offset:21664
    v_mfma_f32_16x16x32_bf16 v[40:43], v[108:111], v[80:83], v[40:43]
    ds_read_b64_tr_b16 v[142:143], v160 offset:23456
    v_mfma_f32_16x16x32_bf16 v[44:47], v[108:111], v[84:87], v[44:47]
    ds_read_b64_tr_b16 v[144:145], v160 offset:7232
    ds_read_b64_tr_b16 v[146:147], v160 offset:9024
    s_waitcnt lgkmcnt(12)
    v_mfma_f32_16x16x32_bf16 v[48:51], v[112:115], v[80:83], v[48:51]
    ds_read_b64_tr_b16 v[148:149], v160 offset:21696
    v_mfma_f32_16x16x32_bf16 v[52:55], v[112:115], v[84:87], v[52:55]
    ds_read_b64_tr_b16 v[150:151], v160 offset:23488
    v_mfma_f32_16x16x32_bf16 v[56:59], v[116:119], v[80:83], v[56:59]
    v_mfma_f32_16x16x32_bf16 v[60:63], v[116:119], v[84:87], v[60:63]
    s_waitcnt lgkmcnt(8)
    v_mfma_f32_16x16x32_bf16 v[16:19], v[128:131], v[88:91], v[16:19]
    ds_read_b128 v[8:11], v5 offset:0
    v_mfma_f32_16x16x32_bf16 v[20:23], v[128:131], v[92:95], v[20:23]
    ds_read_b128 v[12:15], v5 offset:256
    ds_read_b128 v[96:99], v4 offset:0
    v_mfma_f32_16x16x32_bf16 v[24:27], v[132:135], v[88:91], v[24:27]
    ds_read_b128 v[100:103], v4 offset:64
    v_mfma_f32_16x16x32_bf16 v[28:31], v[132:135], v[92:95], v[28:31]
    ds_read_b128 v[104:107], v4 offset:128
    ds_read_b128 v[108:111], v4 offset:192
    s_waitcnt lgkmcnt(10)
    v_mfma_f32_16x16x32_bf16 v[32:35], v[136:139], v[88:91], v[32:35]
    ds_read_b128 v[112:115], v4 offset:256
    v_mfma_f32_16x16x32_bf16 v[36:39], v[136:139], v[92:95], v[36:39]
    ds_read_b128 v[116:119], v4 offset:320
    ds_read_b128 v[120:123], v4 offset:384
    v_mfma_f32_16x16x32_bf16 v[40:43], v[140:143], v[88:91], v[40:43]
    ds_read_b128 v[124:127], v4 offset:448
    v_mfma_f32_16x16x32_bf16 v[44:47], v[140:143], v[92:95], v[44:47]
    s_waitcnt lgkmcnt(10)
    v_mfma_f32_16x16x32_bf16 v[48:51], v[144:147], v[88:91], v[48:51]
    v_mfma_f32_16x16x32_bf16 v[52:55], v[144:147], v[92:95], v[52:55]
    v_mfma_f32_16x16x32_bf16 v[56:59], v[148:151], v[88:91], v[56:59]
    v_mfma_f32_16x16x32_bf16 v[60:63], v[148:151], v[92:95], v[60:63]
    s_nop 4
    s_branch p4_epi
p4_a:
    s_mov_b32 s64, 0
    s_mov_b32 s65, 0
    s_mov_b32 s66, 0
    v_mov_b32 v160, v2
    v_mov_b32 v161, v3
    s_barrier
    ds_read_b128 v[80:83], v161 offset:0
    ds_read_b128 v[84:87], v161 offset:1024
    ds_read_b64_tr_b16 v[96:97], v160 offset:0
    ds_read_b64_tr_b16 v[98:99], v160 offset:1792
    ds_read_b64_tr_b16 v[100:101], v160 offset:14464
    ds_read_b64_tr_b16 v[102:103], v160 offset:16256
    ds_read_b64_tr_b16 v[104:105], v160 offset:32
    ds_read_b64_tr_b16 v[106:107], v160 offset:1824
    ds_read_b64_tr_b16 v[108:109], v160 offset:14496
    ds_read_b64_tr_b16 v[110:111], v160 offset:16288
    ds_read_b64_tr_b16 v[112:113], v160 offset:64
    ds_read_b64_tr_b16 v[114:115], v160 offset:1856
    ds_read_b64_tr_b16 v[116:117], v160 offset:14528
    ds_read_b64_tr_b16 v[118:119], v160 offset:16320
    ds_read_b64_tr_b16 v[120:121], v160 offset:96
    ds_read_b64_tr_b16 v[122:123], v160 offset:1888
    ds_read_b64_tr_b16 v[124:125], v160 offset:14560
    ds_read_b64_tr_b16 v[126:127], v160 offset:16352
p4_loop0:
    s_waitcnt lgkmcnt(12)
    v_mfma_f32_16x16x32_bf16 v[16:19], v[96:99], v[80:83], v[16:19]
    ds_read_b128 v[88:91], v161 offset:2048
    v_mfma_f32_16x16x32_bf16 v[20:23], v[96:99], v[84:87], v[20:23]
    ds_read_b128 v[92:95], v161 offset:3072
    ds_read_b64_tr_b16 v[128:129], v160 offset:7168
    v_mfma_f32_16x16x32_bf16 v[24:27], v[100:103], v[80:83], v[24:27]
    ds_read_b64_tr_b16 v[130:131], v160 offset:8960
    v_mfma_f32_16x16x32_bf16 v[28:31], v[100:103], v[84:87], v[28:31]
    ds_read_b64_tr_b16 v[132:133], v160 offset:21632
    ds_read_b64_tr_b16 v[134:135], v160 offset:23424
    s_waitcnt lgkmcnt(14)
    v_mfma_f32_16x16x32_bf16 v[32:35], v[104:107], v[80:83], v[32:35]
    ds_read_b64_tr_b16 v[136:137], v160 offset:7200
    v_mfma_f32_16x16x32_bf16 v[36:39], v[104:107], v[84:87], v[36:39]
    ds_read_b64_tr_b16 v[138:139], v160 offset:8992
    ds_read_b64_tr_b16 v[140:141], v160 offset:21664
    v_mfma_f32_16x16x32_bf16 v[40:43], v[108:111], v[80:83], v[40:43]
    ds_read_b64_tr_b16 v[142:143], v160 offset:23456
    v_mfma_f32_16x16x32_bf16 v[44:47], v[108:111], v[84:87], v[44:47]
    ds_read_b64_tr_b16 v[144:145], v160 offset:7232
    ds_read_b64_tr_b16 v[146:147], v160 offset:9024
    s_waitcnt lgkmcnt(15)
    v_mfma_f32_16x16x32_bf16 v[48:51], v[112:115], v[80:83], v[48:51]
    ds_read_b64_tr_b16 v[148:149], v160 offset:21696
    v_mfma_f32_16x16x32_bf16 v[52:55], v[112:115], v[84:87], v[52:55]
    ds_read_b64_tr_b16 v[150:151], v160 offset:23488
    ds_read_b64_tr_b16 v[152:153], v160 offset:7264
    v_mfma_f32_16x16x32_bf16 v[56:59], v[116:119], v[80:83], v[56:59]
    ds_read_b64_tr_b16 v[154:155], v160 offset:9056
    v_mfma_f32_16x16x32_bf16 v[60:63], v[116:119], v[84:87], v[60:63]
    ds_read_b64_tr_b16 v[156:157], v160 offset:21728
    ds_read_b64_tr_b16 v[158:159], v160 offset:23520
    s_waitcnt lgkmcnt(15)
    v_mfma_f32_16x16x32_bf16 v[64:67], v[120:123], v[80:83], v[64:67]
    v_mfma_f32_16x16x32_bf16 v[68:71], v[120:123], v[84:87], v[68:71]
    v_mfma_f32_16x16x32_bf16 v[72:75], v[124:127], v[80:83], v[72:75]
    v_mfma_f32_16x16x32_bf16 v[76:79], v[124:127], v[84:87], v[76:79]
    s_add_u32 s65, s65, 32768
    s_and_b32 s65, s65, 0x1ffff
    s_xor_b32 s66, s66, 16384
    s_add_u32 s64, s64, 1
    s_cmp_eq_u32 s64, 5
    s_cselect_b32 s66, 0xffff8000, s66
    s_waitcnt lgkmcnt(12)
    v_mfma_f32_16x16x32_bf16 v[16:19], v[128:131], v[88:91], v[16:19]
    v_mfma_f32_16x16x32_bf16 v[20:23], v[128:131], v[92:95], v[20:23]
    v_mfma_f32_16x16x32_bf16 v[24:27], v[132:135], v[88:91], v[24:27]
    v_mfma_f32_16x16x32_bf16 v[28:31], v[132:135], v[92:95], v[28:31]
    s_waitcnt lgkmcnt(0)
    s_barrier
    v_add_u32 v160, s65, v2
    v_add_u32 v161, s66, v3
    ds_read_b128 v[80:83], v161 offset:0
    ds_read_b128 v[84:87], v161 offset:1024
    v_mfma_f32_16x16x32_bf16 v[32:35], v[136:139], v[88:91], v[32:35]
    ds_read_b64_tr_b16 v[96:97], v160 offset:0
    ds_read_b64_tr_b16 v[98:99], v160 offset:1792
    v_mfma_f32_16x16x32_bf16 v[36:39], v[136:139], v[92:95], v[36:39]
    ds_read_b64_tr_b16 v[100:101], v160 offset:14464
    ds_read_b64_tr_b16 v[102:103], v160 offset:16256
    v_mfma_f32_16x16x32_bf16 v[40:43], v[140:143], v[88:91], v[40:43]
    ds_read_b64_tr_b16 v[104:105], v160 offset:32
    ds_read_b64_tr_b16 v[106:107], v160 offset:1824
    v_mfma_f32_16x16x32_bf16 v[44:47], v[140:143], v[92:95], v[44:47]
    ds_read_b64_tr_b16 v[108:109], v160 offset:14496
    ds_read_b64_tr_b16 v[110:111], v160 offset:16288
    v_mfma_f32_16x16x32_bf16 v[48:51], v[144:147], v[88:91], v[48:51]
    ds_read_b64_tr_b16 v[112:113], v160 offset:64
    ds_read_b64_tr_b16 v[114:115], v160 offset:1856
    v_mfma_f32_16x16x32_bf16 v[52:55], v[144:147], v[92:95], v[52:55]
    ds_read_b64_tr_b16 v[116:117], v160 offset:14528
    ds_read_b64_tr_b16 v[118:119], v160 offset:16320
    v_mfma_f32_16x16x32_bf16 v[56:59], v[148:151], v[88:91], v[56:59]
    ds_read_b64_tr_b16 v[120:121], v160 offset:96
    ds_read_b64_tr_b16 v[122:123], v160 offset:1888
    v_mfma_f32_16x16x32_bf16 v[60:63], v[148:151], v[92:95], v[60:63]
    ds_read_b64_tr_b16 v[124:125], v160 offset:14560
    ds_read_b64_tr_b16 v[126:127], v160 offset:16352
    v_mfma_f32_16x16x32_bf16 v[64:67], v[152:155], v[88:91], v[64:67]
    v_mfma_f32_16x16x32_bf16 v[68:71], v[152:155], v[92:95], v[68:71]
    v_mfma_f32_16x16x32_bf16 v[72:75], v[156:159], v[88:91], v[72:75]
    v_mfma_f32_16x16x32_bf16 v[76:79], v[156:159], v[92:95], v[76:79]
    s_cmp_lt_u32 s64, 6
    s_cbranch_scc1 p4_loop0
    s_waitcnt lgkmcnt(12)
    v_mfma_f32_16x16x32_bf16 v[16:19], v[96:99], v[80:83], v[16:19]
    ds_read_b128 v[88:91], v161 offset:2048
    v_mfma_f32_16x16x32_bf16 v[20:23], v[96:99], v[84:87], v[20:23]
    ds_read_b128 v[92:95], v161 offset:3072
    ds_read_b64_tr_b16 v[128:129], v160 offset:7168
    v_mfma_f32_16x16x32_bf16 v[24:27], v[100:103], v[80:83], v[24:27]
    ds_read_b64_tr_b16 v[130:131], v160 offset:8960
    v_mfma_f32_16x16x32_bf16 v[28:31], v[100:103], v[84:87], v[28:31]
    ds_read_b64_tr_b16 v[132:133], v160 offset:21632
    ds_read_b64_tr_b16 v[134:135], v160 offset:23424
    s_waitcnt lgkmcnt(14)
    v_mfma_f32_16x16x32_bf16 v[32:35], v[104:107], v[80:83], v[32:35]
    ds_read_b64_tr_b16 v[136:137], v160 offset:7200
    v_mfma_f32_16x16x32_bf16 v[36:39], v[104:107], v[84:87], v[36:39]
    ds_read_b64_tr_b16 v[138:139], v160 offset:8992
    ds_read_b64_tr_b16 v[140:141], v160 offset:21664
    v_mfma_f32_16x16x32_bf16 v[40:43], v[108:111], v[80:83], v[40:43]
    ds_read_b64_tr_b16 v[142:143], v160 offset:23456
    v_mfma_f32_16x16x32_bf16 v[44:47], v[108:111], v[84:87], v[44:47]
    ds_read_b64_tr_b16 v[144:145], v160 offset:7232
    ds_read_b64_tr_b16 v[146:147], v160 offset:9024
    s_waitcnt lgkmcnt(15)
    v_mfma_f32_16x16x32_bf16 v[48:51], v[112:115], v[80:83], v[48:51]
    ds_read_b64_tr_b16 v[148:149], v160 offset:21696
    v_mfma_f32_16x16x32_bf16 v[52:55], v[112:115], v[84:87], v[52:55]
    ds_read_b64_tr_b16 v[150:151], v160 offset:23488
    ds_read_b64_tr_b16 v[152:153], v160 offset:7264
    v_mfma_f32_16x16x32_bf16 v[56:59], v[116:119], v[80:83], v[56:59]
    ds_read_b64_tr_b16 v[154:155], v160 offset:9056
    v_mfma_f32_16x16x32_bf16 v[60:63], v[116:119], v[84:87], v[60:63]
    ds_read_b64_tr_b16 v[156:157], v160 offset:21728
    ds_read_b64_tr_b16 v[158:159], v160 offset:23520
    s_waitcnt lgkmcnt(15)
    v_mfma_f32_16x16x32_bf16 v[64:67], v[120:123], v[80:83], v[64:67]
    v_mfma_f32_16x16x32_bf16 v[68:71], v[120:123], v[84:87], v[68:71]
    v_mfma_f32_16x16x32_bf16 v[72:75], v[124:127], v[80:83], v[72:75]
    v_mfma_f32_16x16x32_bf16 v[76:79], v[124:127], v[84:87], v[76:79]
    s_waitcnt lgkmcnt(12)
    v_mfma_f32_16x16x32_bf16 v[16:19], v[128:131], v[88:91], v[16:19]
    ds_read_b128 v[8:11], v5 offset:0
    v_mfma_f32_16x16x32_bf16 v[20:23], v[128:131], v[92:95], v[20:23]
    ds_read_b128 v[12:15], v5 offset:256
    ds_read_b128 v[96:99], v4 offset:0
    v_mfma_f32_16x16x32_bf16 v[24:27], v[132:135], v[88:91], v[24:27]
    ds_read_b128 v[100:103], v4 offset:64
    v_mfma_f32_16x16x32_bf16 v[28:31], v[132:135], v[92:95], v[28:31]
    ds_read_b128 v[104:107], v4 offset:128
    ds_read_b128 v[108:111], v4 offset:192
    s_waitcnt lgkmcnt(14)
    v_mfma_f32_16x16x32_bf16 v[32:35], v[136:139], v[88:91], v[32:35]
    ds_read_b128 v[112:115], v4 offset:256
    v_mfma_f32_16x16x32_bf16 v[36:39], v[136:139], v[92:95], v[36:39]
    ds_read_b128 v[116:119], v4 offset:320
    ds_read_b128 v[120:123], v4 offset:384
    v_mfma_f32_16x16x32_bf16 v[40:43], v[140:143], v[88:91], v[40:43]
    ds_read_b128 v[124:127], v4 offset:448
    v_mfma_f32_16x16x32_bf16 v[44:47], v[140:143], v[92:95], v[44:47]
    s_waitcnt lgkmcnt(14)
    v_mfma_f32_16x16x32_bf16 v[48:51], v[144:147], v[88:91], v[48:51]
    v_mfma_f32_16x16x32_bf16 v[52:55], v[144:147], v[92:95], v[52:55]
    v_mfma_f32_16x16x32_bf16 v[56:59], v[148:151], v[88:91], v[56:59]
    v_mfma_f32_16x16x32_bf16 v[60:63], v[148:151], v[92:95], v[60:63]
    s_waitcnt lgkmcnt(10)
    v_mfma_f32_16x16x32_bf16 v[64:67], v[152:155], v[88:91], v[64:67]
    v_mfma_f32_16x16x32_bf16 v[68:71], v[152:155], v[92:95], v[68:71]
    v_mfma_f32_16x16x32_bf16 v[72:75], v[156:159], v[88:91], v[72:75]
    v_mfma_f32_16x16x32_bf16 v[76:79], v[156:159], v[92:95], v[76:79]
p4_epi:
    s_waitcnt lgkmcnt(0)
    v_pk_fma_f32 v[16:17], v[96:97], v[8:9], v[16:17] op_sel_hi:[1,0,1]
    v_pk_fma_f32 v[18:19], v[98:99], v[8:9], v[18:19] op_sel_hi:[1,0,1]
    v_pk_fma_f32 v[20:21], v[96:97], v[12:13], v[20:21] op_sel_hi:[1,0,1]
    v_pk_fma_f32 v[22:23], v[98:99], v[12:13], v[22:23] op_sel_hi:[1,0,1]
    v_pk_fma_f32 v[24:25], v[100:101], v[8:9], v[24:25] op_sel_hi:[1,0,1]
    v_pk_fma_f32 v[26:27], v[102:103], v[8:9], v[26:27] op_sel_hi:[1,0,1]
    v_pk_fma_f32 v[28:29], v[100:101], v[12:13], v[28:29] op_sel_hi:[1,0,1]
    v_pk_fma_f32 v[30:31], v[102:103], v[12:13], v[30:31] op_sel_hi:[1,0,1]
    v_pk_mul_f32 v[128:129], v[16:17], v[8:9] op_sel:[0,1] op_sel_hi:[1,1]
    v_pk_mul_f32 v[130:131], v[18:19], v[8:9] op_sel:[0,1] op_sel_hi:[1,1]
    v_pk_mul_f32 v[132:133], v[20:21], v[12:13] op_sel:[0,1] op_sel_hi:[1,1]
    v_pk_mul_f32 v[134:135], v[22:23], v[12:13] op_sel:[0,1] op_sel_hi:[1,1]
    v_exp_f32 v128, v128
    v_exp_f32 v129, v129
    v_exp_f32 v130, v130
    v_exp_f32 v131, v131
    v_exp_f32 v132, v132
    v_exp_f32 v133, v133
    v_exp_f32 v134, v134
    v_exp_f32 v135, v135
    v_pk_mul_f32 v[16:17], v[16:17], v[24:25]
    v_pk_mul_f32 v[18:19], v[18:19], v[26:27]
    v_pk_mul_f32 v[20:21], v[20:21], v[28:29]
    v_pk_mul_f32 v[22:23], v[22:23], v[30:31]
    v_pk_fma_f32 v[128:129], v[128:129], v[10:11], v[10:11] op_sel_hi:[1,0,0]
    v_pk_fma_f32 v[130:131], v[130:131], v[10:11], v[10:11] op_sel_hi:[1,0,0]
    v_pk_fma_f32 v[132:133], v[132:133], v[14:15], v[14:15] op_sel_hi:[1,0,0]
    v_pk_fma_f32 v[134:135], v[134:135], v[14:15], v[14:15] op_sel_hi:[1,0,0]
    v_rcp_f32 v128, v128
    v_rcp_f32 v129, v129
    v_rcp_f32 v130, v130
    v_rcp_f32 v131, v131
    v_rcp_f32 v132, v132
    v_rcp_f32 v133, v133
    v_rcp_f32 v134, v134
    v_rcp_f32 v135, v135
    v_pk_mul_f32 v[16:17], v[16:17], v[128:129]
    v_pk_mul_f32 v[18:19], v[18:19], v[130:131]
    v_pk_mul_f32 v[20:21], v[20:21], v[132:133]
    v_pk_mul_f32 v[22:23], v[22:23], v[134:135]
    v_cvt_pk_bf16_f32 v24, v16, v17
    v_cvt_pk_bf16_f32 v25, v18, v19
    v_cvt_pk_bf16_f32 v26, v20, v21
    v_cvt_pk_bf16_f32 v27, v22, v23
    s_nop 0
    v_permlane32_swap_b32 v24, v26
    v_permlane32_swap_b32 v25, v27
    buffer_store_dwordx4 v[24:27], v162, s[12:15], s68 offen sc1
    v_pk_fma_f32 v[32:33], v[104:105], v[8:9], v[32:33] op_sel_hi:[1,0,1]
    v_pk_fma_f32 v[34:35], v[106:107], v[8:9], v[34:35] op_sel_hi:[1,0,1]
    v_pk_fma_f32 v[36:37], v[104:105], v[12:13], v[36:37] op_sel_hi:[1,0,1]
    v_pk_fma_f32 v[38:39], v[106:107], v[12:13], v[38:39] op_sel_hi:[1,0,1]
    v_pk_fma_f32 v[40:41], v[108:109], v[8:9], v[40:41] op_sel_hi:[1,0,1]
    v_pk_fma_f32 v[42:43], v[110:111], v[8:9], v[42:43] op_sel_hi:[1,0,1]
    v_pk_fma_f32 v[44:45], v[108:109], v[12:13], v[44:45] op_sel_hi:[1,0,1]
    v_pk_fma_f32 v[46:47], v[110:111], v[12:13], v[46:47] op_sel_hi:[1,0,1]
    v_pk_mul_f32 v[136:137], v[32:33], v[8:9] op_sel:[0,1] op_sel_hi:[1,1]
    v_pk_mul_f32 v[138:139], v[34:35], v[8:9] op_sel:[0,1] op_sel_hi:[1,1]
    v_pk_mul_f32 v[140:141], v[36:37], v[12:13] op_sel:[0,1] op_sel_hi:[1,1]
    v_pk_mul_f32 v[142:143], v[38:39], v[12:13] op_sel:[0,1] op_sel_hi:[1,1]
    v_exp_f32 v136, v136
    v_exp_f32 v137, v137
    v_exp_f32 v138, v138
    v_exp_f32 v139, v139
    v_exp_f32 v140, v140
    v_exp_f32 v141, v141
    v_exp_f32 v142, v142
    v_exp_f32 v143, v143
    v_pk_mul_f32 v[32:33], v[32:33], v[40:41]
    v_pk_mul_f32 v[34:35], v[34:35], v[42:43]
    v_pk_mul_f32 v[36:37], v[36:37], v[44:45]
    v_pk_mul_f32 v[38:39], v[38:39], v[46:47]
    v_pk_fma_f32 v[136:137], v[136:137], v[10:11], v[10:11] op_sel_hi:[1,0,0]
    v_pk_fma_f32 v[138:139], v[138:139], v[10:11], v[10:11] op_sel_hi:[1,0,0]
    v_pk_fma_f32 v[140:141], v[140:141], v[14:15], v[14:15] op_sel_hi:[1,0,0]
    v_pk_fma_f32 v[142:143], v[142:143], v[14:15], v[14:15] op_sel_hi:[1,0,0]
    v_rcp_f32 v136, v136
    v_rcp_f32 v137, v137
    v_rcp_f32 v138, v138
    v_rcp_f32 v139, v139
    v_rcp_f32 v140, v140
    v_rcp_f32 v141, v141
    v_rcp_f32 v142, v142
    v_rcp_f32 v143, v143
    v_pk_mul_f32 v[32:33], v[32:33], v[136:137]
    v_pk_mul_f32 v[34:35], v[34:35], v[138:139]
    v_pk_mul_f32 v[36:37], v[36:37], v[140:141]
    v_pk_mul_f32 v[38:39], v[38:39], v[142:143]
    v_cvt_pk_bf16_f32 v40, v32, v33
    v_cvt_pk_bf16_f32 v41, v34, v35
    v_cvt_pk_bf16_f32 v42, v36, v37
    v_cvt_pk_bf16_f32 v43, v38, v39
    s_nop 0
    v_permlane32_swap_b32 v40, v42
    v_permlane32_swap_b32 v41, v43
    buffer_store_dwordx4 v[40:43], v162, s[12:15], s69 offen sc1
    v_pk_fma_f32 v[48:49], v[112:113], v[8:9], v[48:49] op_sel_hi:[1,0,1]
    v_pk_fma_f32 v[50:51], v[114:115], v[8:9], v[50:51] op_sel_hi:[1,0,1]
    v_pk_fma_f32 v[52:53], v[112:113], v[12:13], v[52:53] op_sel_hi:[1,0,1]
    v_pk_fma_f32 v[54:55], v[114:115], v[12:13], v[54:55] op_sel_hi:[1,0,1]
    v_pk_fma_f32 v[56:57], v[116:117], v[8:9], v[56:57] op_sel_hi:[1,0,1]
    v_pk_fma_f32 v[58:59], v[118:119], v[8:9], v[58:59] op_sel_hi:[1,0,1]
    v_pk_fma_f32 v[60:61], v[116:117], v[12:13], v[60:61] op_sel_hi:[1,0,1]
    v_pk_fma_f32 v[62:63], v[118:119], v[12:13], v[62:63] op_sel_hi:[1,0,1]
    v_pk_mul_f32 v[128:129], v[48:49], v[8:9] op_sel:[0,1] op_sel_hi:[1,1]
    v_pk_mul_f32 v[130:131], v[50:51], v[8:9] op_sel:[0,1] op_sel_hi:[1,1]
    v_pk_mul_f32 v[132:133], v[52:53], v[12:13] op_sel:[0,1] op_sel_hi:[1,1]
    v_pk_mul_f32 v[134:135], v[54:55], v[12:13] op_sel:[0,1] op_sel_hi:[1,1]
    v_exp_f32 v128, v128
    v_exp_f32 v129, v129
    v_exp_f32 v130, v130
    v_exp_f32 v131, v131
    v_exp_f32 v132, v132
    v_exp_f32 v133, v133
    v_exp_f32 v134, v134
    v_exp_f32 v135, v135
    v_pk_mul_f32 v[48:49], v[48:49], v[56:57]
    v_pk_mul_f32 v[50:51], v[50:51], v[58:59]
    v_pk_mul_f32 v[52:53], v[52:53], v[60:61]
    v_pk_mul_f32 v[54:55], v[54:55], v[62:63]
    v_pk_fma_f32 v[128:129], v[128:129], v[10:11], v[10:11] op_sel_hi:[1,0,0]
    v_pk_fma_f32 v[130:131], v[130:131], v[10:11], v[10:11] op_sel_hi:[1,0,0]
    v_pk_fma_f32 v[132:133], v[132:133], v[14:15], v[14:15] op_sel_hi:[1,0,0]
    v_pk_fma_f32 v[134:135], v[134:135], v[14:15], v[14:15] op_sel_hi:[1,0,0]
    v_rcp_f32 v128, v128
    v_rcp_f32 v129, v129
    v_rcp_f32 v130, v130
    v_rcp_f32 v131, v131
    v_rcp_f32 v132, v132
    v_rcp_f32 v133, v133
    v_rcp_f32 v134, v134
    v_rcp_f32 v135, v135
    v_pk_mul_f32 v[48:49], v[48:49], v[128:129]
    v_pk_mul_f32 v[50:51], v[50:51], v[130:131]
    v_pk_mul_f32 v[52:53], v[52:53], v[132:133]
    v_pk_mul_f32 v[54:55], v[54:55], v[134:135]
    v_cvt_pk_bf16_f32 v56, v48, v49
    v_cvt_pk_bf16_f32 v57, v50, v51
    v_cvt_pk_bf16_f32 v58, v52, v53
    v_cvt_pk_bf16_f32 v59, v54, v55
    s_nop 0
    v_permlane32_swap_b32 v56, v58
    v_permlane32_swap_b32 v57, v59
    buffer_store_dwordx4 v[56:59], v162, s[12:15], s70 offen sc1
    s_cmp_eq_u32 s34, 1
    s_cbranch_scc1 p4_join
    v_pk_fma_f32 v[64:65], v[120:121], v[8:9], v[64:65] op_sel_hi:[1,0,1]
    v_pk_fma_f32 v[66:67], v[122:123], v[8:9], v[66:67] op_sel_hi:[1,0,1]
    v_pk_fma_f32 v[68:69], v[120:121], v[12:13], v[68:69] op_sel_hi:[1,0,1]
    v_pk_fma_f32 v[70:71], v[122:123], v[12:13], v[70:71] op_sel_hi:[1,0,1]
    v_pk_fma_f32 v[72:73], v[124:125], v[8:9], v[72:73] op_sel_hi:[1,0,1]
    v_pk_fma_f32 v[74:75], v[126:127], v[8:9], v[74:75] op_sel_hi:[1,0,1]
    v_pk_fma_f32 v[76:77], v[124:125], v[12:13], v[76:77] op_sel_hi:[1,0,1]
    v_pk_fma_f32 v[78:79], v[126:127], v[12:13], v[78:79] op_sel_hi:[1,0,1]
    v_pk_mul_f32 v[136:137], v[64:65], v[8:9] op_sel:[0,1] op_sel_hi:[1,1]
    v_pk_mul_f32 v[138:139], v[66:67], v[8:9] op_sel:[0,1] op_sel_hi:[1,1]
    v_pk_mul_f32 v[140:141], v[68:69], v[12:13] op_sel:[0,1] op_sel_hi:[1,1]
    v_pk_mul_f32 v[142:143], v[70:71], v[12:13] op_sel:[0,1] op_sel_hi:[1,1]
    v_exp_f32 v136, v136
    v_exp_f32 v137, v137
    v_exp_f32 v138, v138
    v_exp_f32 v139, v139
    v_exp_f32 v140, v140
    v_exp_f32 v141, v141
    v_exp_f32 v142, v142
    v_exp_f32 v143, v143
    v_pk_mul_f32 v[64:65], v[64:65], v[72:73]
    v_pk_mul_f32 v[66:67], v[66:67], v[74:75]
    v_pk_mul_f32 v[68:69], v[68:69], v[76:77]
    v_pk_mul_f32 v[70:71], v[70:71], v[78:79]
    v_pk_fma_f32 v[136:137], v[136:137], v[10:11], v[10:11] op_sel_hi:[1,0,0]
    v_pk_fma_f32 v[138:139], v[138:139], v[10:11], v[10:11] op_sel_hi:[1,0,0]
    v_pk_fma_f32 v[140:141], v[140:141], v[14:15], v[14:15] op_sel_hi:[1,0,0]
    v_pk_fma_f32 v[142:143], v[142:143], v[14:15], v[14:15] op_sel_hi:[1,0,0]
    v_rcp_f32 v136, v136
    v_rcp_f32 v137, v137
    v_rcp_f32 v138, v138
    v_rcp_f32 v139, v139
    v_rcp_f32 v140, v140
    v_rcp_f32 v141, v141
    v_rcp_f32 v142, v142
    v_rcp_f32 v143, v143
    v_pk_mul_f32 v[64:65], v[64:65], v[136:137]
    v_pk_mul_f32 v[66:67], v[66:67], v[138:139]
    v_pk_mul_f32 v[68:69], v[68:69], v[140:141]
    v_pk_mul_f32 v[70:71], v[70:71], v[142:143]
    v_cvt_pk_bf16_f32 v72, v64, v65
    v_cvt_pk_bf16_f32 v73, v66, v67
    v_cvt_pk_bf16_f32 v74, v68, v69
    v_cvt_pk_bf16_f32 v75, v70, v71
    s_nop 0
    v_permlane32_swap_b32 v72, v74
    v_permlane32_swap_b32 v73, v75
    buffer_store_dwordx4 v[72:75], v162, s[12:15], s71 offen sc1
p4_join:
    s_setprio 0
    s_waitcnt vmcnt(0) lgkmcnt(0)
    s_barrier
    s_cmp_ge_u32 s5, 28
    s_cbranch_scc1 all_done
    s_lshl_b32 s6, s4, 2
    s_and_b32 s32, s5, 3
    s_add_u32 s32, s32, s6
    s_lshr_b32 s33, s5, 2
    s_lshr_b32 s35, s3, 2
    s_lshl_b32 s64, s32, 1
    s_add_u32 s64, s64, s35
    s_and_b32 s6, s58, 1
    s_lshl_b32 s65, s33, 1
    s_add_u32 s65, s65, s6
    s_lshr_b32 s66, s58, 1
    s_mov_b32 s67, 0
    s_add_u32 s16, s54, 0x800000
    s_addc_u32 s17, s55, 0
    s_mov_b32 s18, 0x800
    s_mov_b32 s19, 0x20000
    s_and_b32 s6, s64, 31
    s_mul_i32 s6, s6, 65536
    s_add_u32 s16, s16, s6
    s_addc_u32 s17, s17, 0
    s_add_u32 s7, s54, 0x800000
    s_add_u32 s7, s7, s6
    s_lshr_b32 s7, s7, 19
    s_xor_b32 s7, s7, s4
    s_xor_b32 s7, s7, s88
    s_and_b32 s7, s7, 4
    s_lshl_b32 s7, s7, 11
    s_add_u32 s16, s16, s7
    s_addc_u32 s17, s17, 0
    s_lshl_b32 s6, s65, 1
    s_lshr_b32 s7, s6, 3
    s_lshl_b32 s7, s7, 3
    s_add_u32 s6, s6, s7
    s_lshl_b32 s6, s6, 10
    s_add_u32 s16, s16, s6
    s_addc_u32 s17, s17, 0
    v_and_b32 v165, 15, v0
    v_lshlrev_b32 v165, 4, v165
    v_bfe_u32 v6, v0, 4, 1
    v_lshl_add_u32 v165, v6, 10, v165
    v_lshrrev_b32 v6, 5, v0
    v_lshl_add_u32 v165, v6, 8, v165
    s_lshl_b32 s6, s66, 9
    v_add_u32 v165, s6, v165
    s_lshl_b32 s6, s58, 13
    v_lshrrev_b32 v6, 5, v0
    v_lshlrev_b32 v6, 2, v6
    v_bfe_u32 v7, v0, 2, 2
    v_add_u32 v6, v6, v7
    v_lshlrev_b32 v2, 7, v6
    v_bfe_u32 v6, v0, 3, 1
    v_lshl_add_u32 v2, v6, 6, v2
    v_bfe_u32 v6, v0, 4, 1
    v_lshl_add_u32 v2, v6, 5, v2
    v_and_b32 v6, 3, v0
    v_lshl_add_u32 v2, v6, 3, v2
    v_add_u32 v2, s6, v2
    v_xor_b32 v3, 64, v2
    v_add_u32 v10, 65536, v2
    v_add_u32 v11, 65536, v3
    v_add_u32 v9, 131072, v2
    v_add_u32 v164, 131072, v3
    v_and_b32 v6, 31, v0
    v_mul_u32_u24 v4, 896, v6
    v_lshrrev_b32 v6, 5, v0
    v_lshl_add_u32 v4, v6, 4, v4
    s_add_u32 s8, s54, 0xc00000
    s_addc_u32 s9, s55, 0
    s_mov_b32 s10, 0x36000
    s_mov_b32 s11, 0x20000
    s_and_b32 s6, s64, 31
    s_mul_i32 s7, s6, 57
    s_lshr_b32 s7, s7, 9
    s_mul_i32 s7, s7, 32768
    s_mul_i32 s6, s6, 229376
    s_add_u32 s6, s6, s7
    s_add_u32 s8, s8, s6
    s_addc_u32 s9, s9, 0
    s_add_u32 s7, s54, 0xc00000
    s_add_u32 s7, s7, s6
    s_lshr_b32 s7, s7, 19
    s_xor_b32 s7, s7, s4
    s_xor_b32 s7, s7, s88
    s_and_b32 s7, s7, 4
    s_lshl_b32 s7, s7, 11
    s_add_u32 s8, s8, s7
    s_addc_u32 s9, s9, 0
    s_mul_i32 s70, s58, 28
    s_mov_b32 s12, s50
    s_mov_b32 s13, s51
    s_mov_b32 s14, 0x1c0000
    s_mov_b32 s15, 0x20000
    s_mul_i32 s69, s64, 28672
    s_lshl_b32 s7, s65, 6
    s_add_u32 s69, s69, s7
    s_lshl_b32 s7, s66, 5
    s_add_u32 s69, s69, s7
    s_mul_i32 s6, s35, 24576
    s_add_u32 s6, s6, 32768
    v_add_u32 v5, s6, v1
    s_mul_i32 s6, s58, 6144
    v_add_u32 v8, s6, v5
    ds_read_b64_tr_b16 v[100:101], v9 offset:0
    ds_read_b64_tr_b16 v[102:103], v9 offset:1024
    ds_read_b64_tr_b16 v[104:105], v164 offset:0
    ds_read_b64_tr_b16 v[106:107], v164 offset:1024
    ds_read_b64_tr_b16 v[108:109], v9 offset:2048
    ds_read_b64_tr_b16 v[110:111], v9 offset:3072
    ds_read_b64_tr_b16 v[112:113], v164 offset:2048
    ds_read_b64_tr_b16 v[114:115], v164 offset:3072
    ds_read_b64_tr_b16 v[116:117], v9 offset:4096
    ds_read_b64_tr_b16 v[118:119], v9 offset:5120
    ds_read_b64_tr_b16 v[120:121], v164 offset:4096
    ds_read_b64_tr_b16 v[122:123], v164 offset:5120
    s_waitcnt lgkmcnt(0)
    ds_read_b64_tr_b16 v[124:125], v9 offset:6144
    ds_read_b64_tr_b16 v[126:127], v9 offset:7168
    ds_read_b64_tr_b16 v[128:129], v164 offset:6144
    ds_read_b64_tr_b16 v[130:131], v164 offset:7168
    ds_read_b64_tr_b16 v[132:133], v2 offset:0
    ds_read_b64_tr_b16 v[134:135], v2 offset:1024
    ds_read_b64_tr_b16 v[136:137], v3 offset:0
    ds_read_b64_tr_b16 v[138:139], v3 offset:1024
    ds_read_b64_tr_b16 v[140:141], v2 offset:2048
    ds_read_b64_tr_b16 v[142:143], v2 offset:3072
    ds_read_b64_tr_b16 v[144:145], v3 offset:2048
    ds_read_b64_tr_b16 v[146:147], v3 offset:3072
    s_waitcnt lgkmcnt(0)
    ds_read_b64_tr_b16 v[148:149], v2 offset:4096
    ds_read_b64_tr_b16 v[150:151], v2 offset:5120
    ds_read_b64_tr_b16 v[152:153], v3 offset:4096
    ds_read_b64_tr_b16 v[154:155], v3 offset:5120
    ds_read_b64_tr_b16 v[156:157], v2 offset:6144
    ds_read_b64_tr_b16 v[158:159], v2 offset:7168
    ds_read_b64_tr_b16 v[160:161], v3 offset:6144
    ds_read_b64_tr_b16 v[162:163], v3 offset:7168
    v_mov_b32 v16, 0
    v_mov_b32 v17, 0
    v_mov_b32 v18, 0
    v_mov_b32 v19, 0
    v_mov_b32 v20, 0
    v_mov_b32 v21, 0
    v_mov_b32 v22, 0
    v_mov_b32 v23, 0
    v_mov_b32 v24, 0
    v_mov_b32 v25, 0
    v_mov_b32 v26, 0
    v_mov_b32 v27, 0
    v_mov_b32 v28, 0
    v_mov_b32 v29, 0
    v_mov_b32 v30, 0
    v_mov_b32 v31, 0
    v_mov_b32 v32, 0
    v_mov_b32 v33, 0
    v_mov_b32 v34, 0
    v_mov_b32 v35, 0
    v_mov_b32 v36, 0
    v_mov_b32 v37, 0
    v_mov_b32 v38, 0
    v_mov_b32 v39, 0
    v_mov_b32 v40, 0
    v_mov_b32 v41, 0
    v_mov_b32 v42, 0
    v_mov_b32 v43, 0
    v_mov_b32 v44, 0
    v_mov_b32 v45, 0
    v_mov_b32 v46, 0
    v_mov_b32 v47, 0
    s_waitcnt lgkmcnt(0)
    s_barrier
    s_barrier
    s_lshl_b32 s68, s67, 2
    s_add_u32 s68, s68, s70
    s_lshr_b32 s7, s68, 3
    s_lshl_b32 s7, s7, 3
    s_add_u32 s68, s68, s7
    s_lshl_b32 s68, s68, 10
    buffer_load_dwordx4 v[88:91], v1, s[8:11], s68 offen offset:0 sc1
    buffer_load_dwordx4 v[92:95], v1, s[8:11], s68 offen offset:1024 sc1
    buffer_load_dwordx4 v[96:99], v1, s[8:11], s68 offen offset:2048 sc1
    buffer_load_dwordx4 v[76:79], v1, s[8:11], s68 offen offset:3072 sc1
    s_add_u32 s67, s67, 1
    s_cmp_eq_u32 s67, 7
    s_cselect_b32 s67, 0, s67
    s_lshl_b32 s68, s67, 2
    s_add_u32 s68, s68, s70
    s_lshr_b32 s7, s68, 3
    s_lshl_b32 s7, s7, 3
    s_add_u32 s68, s68, s7
    s_lshl_b32 s68, s68, 10
    buffer_load_dwordx4 v[12:15], v1, s[8:11], s68 offen offset:0 sc1
    s_waitcnt vmcnt(4)
    v_mfma_f32_32x32x16_bf16 v[16:31], v[100:103], v[88:91], v[16:31]
    v_mfma_f32_32x32x16_bf16 v[32:47], v[104:107], v[88:91], v[32:47]
    buffer_load_dwordx4 v[88:91], v1, s[8:11], s68 offen offset:1024 sc1
    s_waitcnt vmcnt(4)
    v_mfma_f32_32x32x16_bf16 v[16:31], v[108:111], v[92:95], v[16:31]
    v_mfma_f32_32x32x16_bf16 v[32:47], v[112:115], v[92:95], v[32:47]
    buffer_load_dwordx4 v[100:103], v1, s[8:11], s68 offen offset:2048 sc1
    s_waitcnt vmcnt(4)
    v_mfma_f32_32x32x16_bf16 v[16:31], v[116:119], v[96:99], v[16:31]
    v_mfma_f32_32x32x16_bf16 v[32:47], v[120:123], v[96:99], v[32:47]
    buffer_load_dwordx4 v[104:107], v1, s[8:11], s68 offen offset:3072 sc1
    s_add_u32 s67, s67, 1
    s_cmp_eq_u32 s67, 7
    s_cselect_b32 s67, 0, s67
    s_waitcnt vmcnt(4)
    v_mfma_f32_32x32x16_bf16 v[16:31], v[124:127], v[76:79], v[16:31]
    v_mfma_f32_32x32x16_bf16 v[32:47], v[128:131], v[76:79], v[32:47]
    s_lshl_b32 s68, s67, 2
    s_add_u32 s68, s68, s70
    s_lshr_b32 s7, s68, 3
    s_lshl_b32 s7, s7, 3
    s_add_u32 s68, s68, s7
    s_lshl_b32 s68, s68, 10
    buffer_load_dwordx4 v[92:95], v1, s[8:11], s68 offen offset:0 sc1
    s_waitcnt vmcnt(4)
    v_mfma_f32_32x32x16_bf16 v[16:31], v[132:135], v[12:15], v[16:31]
    v_mfma_f32_32x32x16_bf16 v[32:47], v[136:139], v[12:15], v[32:47]
    buffer_load_dwordx4 v[108:111], v1, s[8:11], s68 offen offset:1024 sc1
    s_waitcnt vmcnt(4)
    v_mfma_f32_32x32x16_bf16 v[16:31], v[140:143], v[88:91], v[16:31]
    v_mfma_f32_32x32x16_bf16 v[32:47], v[144:147], v[88:91], v[32:47]
    buffer_load_dwordx4 v[112:115], v1, s[8:11], s68 offen offset:2048 sc1
    s_waitcnt vmcnt(4)
    v_mfma_f32_32x32x16_bf16 v[16:31], v[148:151], v[100:103], v[16:31]
    ds_read_b64_tr_b16 v[64:65], v2 offset:32768
    ds_read_b64_tr_b16 v[66:67], v2 offset:33792
    ds_read_b64_tr_b16 v[68:69], v3 offset:32768
    ds_read_b64_tr_b16 v[70:71], v3 offset:33792
    v_mfma_f32_32x32x16_bf16 v[32:47], v[152:155], v[100:103], v[32:47]
    buffer_load_dwordx4 v[96:99], v1, s[8:11], s68 offen offset:3072 sc1
    s_add_u32 s67, s67, 1
    s_cmp_eq_u32 s67, 7
    s_cselect_b32 s67, 0, s67
    s_waitcnt vmcnt(4)
    v_mfma_f32_32x32x16_bf16 v[16:31], v[156:159], v[104:107], v[16:31]
    ds_read_b64_tr_b16 v[48:49], v2 offset:34816
    ds_read_b64_tr_b16 v[50:51], v2 offset:35840
    ds_read_b64_tr_b16 v[52:53], v3 offset:34816
    ds_read_b64_tr_b16 v[54:55], v3 offset:35840
    v_mfma_f32_32x32x16_bf16 v[32:47], v[160:163], v[104:107], v[32:47]
    s_lshl_b32 s68, s67, 2
    s_add_u32 s68, s68, s70
    s_lshr_b32 s7, s68, 3
    s_lshl_b32 s7, s7, 3
    s_add_u32 s68, s68, s7
    s_lshl_b32 s68, s68, 10
    buffer_load_dwordx4 v[116:119], v1, s[8:11], s68 offen offset:0 sc1
    s_waitcnt vmcnt(4) lgkmcnt(4)
    v_mfma_f32_32x32x16_bf16 v[16:31], v[64:67], v[92:95], v[16:31]
    ds_read_b64_tr_b16 v[56:57], v2 offset:36864
    ds_read_b64_tr_b16 v[58:59], v2 offset:37888
    ds_read_b64_tr_b16 v[60:61], v3 offset:36864
    ds_read_b64_tr_b16 v[62:63], v3 offset:37888
    v_mfma_f32_32x32x16_bf16 v[32:47], v[68:71], v[92:95], v[32:47]
    buffer_load_dwordx4 v[120:123], v1, s[8:11], s68 offen offset:1024 sc1
    s_waitcnt vmcnt(4) lgkmcnt(4)
    v_mfma_f32_32x32x16_bf16 v[16:31], v[48:51], v[108:111], v[16:31]
    ds_read_b64_tr_b16 v[64:65], v2 offset:38912
    ds_read_b64_tr_b16 v[66:67], v2 offset:39936
    ds_read_b64_tr_b16 v[68:69], v3 offset:38912
    ds_read_b64_tr_b16 v[70:71], v3 offset:39936
    v_mfma_f32_32x32x16_bf16 v[32:47], v[52:55], v[108:111], v[32:47]
    buffer_load_dwordx4 v[76:79], v1, s[8:11], s68 offen offset:2048 sc1
    s_waitcnt vmcnt(4) lgkmcnt(4)
    v_mfma_f32_32x32x16_bf16 v[16:31], v[56:59], v[112:115], v[16:31]
    ds_read_b64_tr_b16 v[48:49], v10 offset:0
    ds_read_b64_tr_b16 v[50:51], v10 offset:1024
    ds_read_b64_tr_b16 v[52:53], v11 offset:0
    ds_read_b64_tr_b16 v[54:55], v11 offset:1024
    v_mfma_f32_32x32x16_bf16 v[32:47], v[60:63], v[112:115], v[32:47]
    buffer_load_dwordx4 v[124:127], v1, s[8:11], s68 offen offset:3072 sc1
    s_add_u32 s67, s67, 1
    s_cmp_eq_u32 s67, 7
    s_cselect_b32 s67, 0, s67
    s_waitcnt vmcnt(4) lgkmcnt(4)
    v_mfma_f32_32x32x16_bf16 v[16:31], v[64:67], v[96:99], v[16:31]
    ds_read_b64_tr_b16 v[56:57], v10 offset:2048
    ds_read_b64_tr_b16 v[58:59], v10 offset:3072
    ds_read_b64_tr_b16 v[60:61], v11 offset:2048
    ds_read_b64_tr_b16 v[62:63], v11 offset:3072
    v_mfma_f32_32x32x16_bf16 v[32:47], v[68:71], v[96:99], v[32:47]
    s_lshl_b32 s68, s67, 2
    s_add_u32 s68, s68, s70
    s_lshr_b32 s7, s68, 3
    s_lshl_b32 s7, s7, 3
    s_add_u32 s68, s68, s7
    s_lshl_b32 s68, s68, 10
    buffer_load_dwordx4 v[128:131], v1, s[8:11], s68 offen offset:0 sc1
    s_waitcnt vmcnt(4) lgkmcnt(4)
    v_mfma_f32_32x32x16_bf16 v[16:31], v[48:51], v[116:119], v[16:31]
    ds_read_b64_tr_b16 v[64:65], v10 offset:4096
    ds_read_b64_tr_b16 v[66:67], v10 offset:5120
    ds_read_b64_tr_b16 v[68:69], v11 offset:4096
    ds_read_b64_tr_b16 v[70:71], v11 offset:5120
    v_mfma_f32_32x32x16_bf16 v[32:47], v[52:55], v[116:119], v[32:47]
    buffer_load_dwordx4 v[12:15], v1, s[8:11], s68 offen offset:1024 sc1
    buffer_load_dwordx4 v[72:75], v165, s[16:19], 0 offen sc1
    s_waitcnt vmcnt(5) lgkmcnt(4)
    v_mfma_f32_32x32x16_bf16 v[16:31], v[56:59], v[120:123], v[16:31]
    ds_read_b64_tr_b16 v[48:49], v10 offset:6144
    ds_read_b64_tr_b16 v[50:51], v10 offset:7168
    ds_read_b64_tr_b16 v[52:53], v11 offset:6144
    ds_read_b64_tr_b16 v[54:55], v11 offset:7168
    v_mfma_f32_32x32x16_bf16 v[32:47], v[60:63], v[120:123], v[32:47]
    buffer_load_dwordx4 v[132:135], v1, s[8:11], s68 offen offset:2048 sc1
    s_waitcnt vmcnt(5) lgkmcnt(4)
    v_mfma_f32_32x32x16_bf16 v[16:31], v[64:67], v[76:79], v[16:31]
    ds_read_b64_tr_b16 v[56:57], v10 offset:32768
    ds_read_b64_tr_b16 v[58:59], v10 offset:33792
    ds_read_b64_tr_b16 v[60:61], v11 offset:32768
    ds_read_b64_tr_b16 v[62:63], v11 offset:33792
    v_mfma_f32_32x32x16_bf16 v[32:47], v[68:71], v[76:79], v[32:47]
    buffer_load_dwordx4 v[136:139], v1, s[8:11], s68 offen offset:3072 sc1
    s_add_u32 s67, s67, 1
    s_cmp_eq_u32 s67, 7
    s_cselect_b32 s67, 0, s67
    s_waitcnt vmcnt(5) lgkmcnt(4)
    v_mfma_f32_32x32x16_bf16 v[16:31], v[48:51], v[124:127], v[16:31]
    ds_read_b64_tr_b16 v[64:65], v10 offset:34816
    ds_read_b64_tr_b16 v[66:67], v10 offset:35840
    ds_read_b64_tr_b16 v[68:69], v11 offset:34816
    ds_read_b64_tr_b16 v[70:71], v11 offset:35840
    v_mfma_f32_32x32x16_bf16 v[32:47], v[52:55], v[124:127], v[32:47]
    s_lshl_b32 s68, s67, 2
    s_add_u32 s68, s68, s70
    s_lshr_b32 s7, s68, 3
    s_lshl_b32 s7, s7, 3
    s_add_u32 s68, s68, s7
    s_lshl_b32 s68, s68, 10
    buffer_load_dwordx4 v[88:91], v1, s[8:11], s68 offen offset:0 sc1
    s_waitcnt vmcnt(5) lgkmcnt(4)
    v_mfma_f32_32x32x16_bf16 v[16:31], v[56:59], v[128:131], v[16:31]
    ds_read_b64_tr_b16 v[48:49], v10 offset:36864
    ds_read_b64_tr_b16 v[50:51], v10 offset:37888
    ds_read_b64_tr_b16 v[52:53], v11 offset:36864
    ds_read_b64_tr_b16 v[54:55], v11 offset:37888
    v_mfma_f32_32x32x16_bf16 v[32:47], v[60:63], v[128:131], v[32:47]
    buffer_load_dwordx4 v[140:143], v1, s[8:11], s68 offen offset:1024 sc1
    s_waitcnt vmcnt(5) lgkmcnt(4)
    v_mfma_f32_32x32x16_bf16 v[16:31], v[64:67], v[12:15], v[16:31]
    ds_read_b64_tr_b16 v[56:57], v10 offset:38912
    ds_read_b64_tr_b16 v[58:59], v10 offset:39936
    ds_read_b64_tr_b16 v[60:61], v11 offset:38912
    ds_read_b64_tr_b16 v[62:63], v11 offset:39936
    v_mfma_f32_32x32x16_bf16 v[32:47], v[68:71], v[12:15], v[32:47]
    buffer_load_dwordx4 v[144:147], v1, s[8:11], s68 offen offset:2048 sc1
    s_waitcnt vmcnt(4) lgkmcnt(4)
    v_mfma_f32_32x32x16_bf16 v[16:31], v[48:51], v[132:135], v[16:31]
    ds_read_b64_tr_b16 v[64:65], v9 offset:0
    ds_read_b64_tr_b16 v[66:67], v9 offset:1024
    ds_read_b64_tr_b16 v[68:69], v164 offset:0
    ds_read_b64_tr_b16 v[70:71], v164 offset:1024
    v_mfma_f32_32x32x16_bf16 v[32:47], v[52:55], v[132:135], v[32:47]
    buffer_load_dwordx4 v[100:103], v1, s[8:11], s68 offen offset:3072 sc1
    s_add_u32 s67, s67, 1
    s_cmp_eq_u32 s67, 7
    s_cselect_b32 s67, 0, s67
    s_waitcnt vmcnt(4) lgkmcnt(4)
    v_mfma_f32_32x32x16_bf16 v[16:31], v[56:59], v[136:139], v[16:31]
    ds_read_b64_tr_b16 v[48:49], v9 offset:2048
    ds_read_b64_tr_b16 v[50:51], v9 offset:3072
    ds_read_b64_tr_b16 v[52:53], v164 offset:2048
    ds_read_b64_tr_b16 v[54:55], v164 offset:3072
    v_mfma_f32_32x32x16_bf16 v[32:47], v[60:63], v[136:139], v[32:47]
    s_lshl_b32 s68, s67, 2
    s_add_u32 s68, s68, s70
    s_lshr_b32 s7, s68, 3
    s_lshl_b32 s7, s7, 3
    s_add_u32 s68, s68, s7
    s_lshl_b32 s68, s68, 10
    buffer_load_dwordx4 v[148:151], v1, s[8:11], s68 offen offset:0 sc1
    s_waitcnt vmcnt(4) lgkmcnt(4)
    v_mfma_f32_32x32x16_bf16 v[16:31], v[64:67], v[88:91], v[16:31]
    ds_read_b64_tr_b16 v[56:57], v9 offset:4096
    ds_read_b64_tr_b16 v[58:59], v9 offset:5120
    ds_read_b64_tr_b16 v[60:61], v164 offset:4096
    ds_read_b64_tr_b16 v[62:63], v164 offset:5120
    v_mfma_f32_32x32x16_bf16 v[32:47], v[68:71], v[88:91], v[32:47]
    buffer_load_dwordx4 v[152:155], v1, s[8:11], s68 offen offset:1024 sc1
    s_waitcnt vmcnt(4) lgkmcnt(4)
    v_mfma_f32_32x32x16_bf16 v[16:31], v[48:51], v[140:143], v[16:31]
    ds_read_b64_tr_b16 v[64:65], v9 offset:6144
    ds_read_b64_tr_b16 v[66:67], v9 offset:7168
    ds_read_b64_tr_b16 v[68:69], v164 offset:6144
    ds_read_b64_tr_b16 v[70:71], v164 offset:7168
    v_mfma_f32_32x32x16_bf16 v[32:47], v[52:55], v[140:143], v[32:47]
    buffer_load_dwordx4 v[104:107], v1, s[8:11], s68 offen offset:2048 sc1
    s_waitcnt vmcnt(4) lgkmcnt(4)
    v_mfma_f32_32x32x16_bf16 v[16:31], v[56:59], v[144:147], v[16:31]
    s_barrier
    ds_read_b64_tr_b16 v[48:49], v2 offset:0
    ds_read_b64_tr_b16 v[50:51], v2 offset:1024
    ds_read_b64_tr_b16 v[52:53], v3 offset:0
    ds_read_b64_tr_b16 v[54:55], v3 offset:1024
    v_mfma_f32_32x32x16_bf16 v[32:47], v[60:63], v[144:147], v[32:47]
    buffer_load_dwordx4 v[156:159], v1, s[8:11], s68 offen offset:3072 sc1
    s_add_u32 s67, s67, 1
    s_cmp_eq_u32 s67, 7
    s_cselect_b32 s67, 0, s67
    s_waitcnt vmcnt(4) lgkmcnt(4)
    v_mfma_f32_32x32x16_bf16 v[16:31], v[64:67], v[100:103], v[16:31]
    ds_read_b64_tr_b16 v[56:57], v2 offset:2048
    ds_read_b64_tr_b16 v[58:59], v2 offset:3072
    ds_read_b64_tr_b16 v[60:61], v3 offset:2048
    ds_read_b64_tr_b16 v[62:63], v3 offset:3072
    v_mfma_f32_32x32x16_bf16 v[32:47], v[68:71], v[100:103], v[32:47]
    s_waitcnt vmcnt(3) lgkmcnt(4)
    v_mfma_f32_32x32x16_bf16 v[16:31], v[48:51], v[148:151], v[16:31]
    ds_read_b64_tr_b16 v[64:65], v2 offset:4096
    ds_read_b64_tr_b16 v[66:67], v2 offset:5120
    ds_read_b64_tr_b16 v[68:69], v3 offset:4096
    ds_read_b64_tr_b16 v[70:71], v3 offset:5120
    v_mfma_f32_32x32x16_bf16 v[32:47], v[52:55], v[148:151], v[32:47]
    v_lshlrev_b32 v80, 16, v72
    v_and_b32 v81, 0xffff0000, v72
    v_lshlrev_b32 v82, 16, v73
    v_and_b32 v83, 0xffff0000, v73
    v_lshlrev_b32 v84, 16, v74
    v_and_b32 v85, 0xffff0000, v74
    v_lshlrev_b32 v86, 16, v75
    v_and_b32 v87, 0xffff0000, v75
    s_waitcnt vmcnt(2) lgkmcnt(4)
    v_mfma_f32_32x32x16_bf16 v[16:31], v[56:59], v[152:155], v[16:31]
    ds_read_b64_tr_b16 v[48:49], v2 offset:6144
    ds_read_b64_tr_b16 v[50:51], v2 offset:7168
    ds_read_b64_tr_b16 v[52:53], v3 offset:6144
    ds_read_b64_tr_b16 v[54:55], v3 offset:7168
    v_mfma_f32_32x32x16_bf16 v[32:47], v[60:63], v[152:155], v[32:47]
    s_waitcnt vmcnt(1) lgkmcnt(4)
    v_mfma_f32_32x32x16_bf16 v[16:31], v[64:67], v[104:107], v[16:31]
    v_mfma_f32_32x32x16_bf16 v[32:47], v[68:71], v[104:107], v[32:47]
    s_waitcnt vmcnt(0) lgkmcnt(0)
    v_mfma_f32_32x32x16_bf16 v[16:31], v[48:51], v[156:159], v[16:31]
    v_mfma_f32_32x32x16_bf16 v[32:47], v[52:55], v[156:159], v[32:47]
    s_cmp_lg_u32 s58, 0
    s_cbranch_scc1 p5_red1
    s_nop 9
    ds_write_b128 v5, v[32:35] offset:6144
    ds_write_b128 v5, v[36:39] offset:7168
    ds_write_b128 v5, v[24:27] offset:14336
    ds_write_b128 v5, v[28:31] offset:15360
    ds_write_b128 v5, v[40:43] offset:22528
    ds_write_b128 v5, v[44:47] offset:23552
    s_branch p5_redj
p5_red1:
    s_cmp_lg_u32 s58, 1
    s_cbranch_scc1 p5_red2
    s_nop 9
    ds_write_b128 v5, v[16:19] offset:0
    ds_write_b128 v5, v[20:23] offset:1024
    ds_write_b128 v5, v[40:43] offset:20480
    ds_write_b128 v5, v[44:47] offset:21504
    ds_write_b128 v5, v[24:27] offset:16384
    ds_write_b128 v5, v[28:31] offset:17408
    v_pk_mul_f32 v[16:17], v[32:33], 1.0 op_sel_hi:[1,0]
    v_pk_mul_f32 v[18:19], v[34:35], 1.0 op_sel_hi:[1,0]
    v_pk_mul_f32 v[20:21], v[36:37], 1.0 op_sel_hi:[1,0]
    v_pk_mul_f32 v[22:23], v[38:39], 1.0 op_sel_hi:[1,0]
    s_branch p5_redj
p5_red2:
    s_cmp_lg_u32 s58, 2
    s_cbranch_scc1 p5_red3
    s_nop 9
    ds_write_b128 v5, v[40:43] offset:18432
    ds_write_b128 v5, v[44:47] offset:19456
    ds_write_b128 v5, v[16:19] offset:2048
    ds_write_b128 v5, v[20:23] offset:3072
    ds_write_b128 v5, v[32:35] offset:10240
    ds_write_b128 v5, v[36:39] offset:11264
    v_pk_mul_f32 v[16:17], v[24:25], 1.0 op_sel_hi:[1,0]
    v_pk_mul_f32 v[18:19], v[26:27], 1.0 op_sel_hi:[1,0]
    v_pk_mul_f32 v[20:21], v[28:29], 1.0 op_sel_hi:[1,0]
    v_pk_mul_f32 v[22:23], v[30:31], 1.0 op_sel_hi:[1,0]
    s_branch p5_redj
p5_red3:
    s_nop 9
    ds_write_b128 v5, v[24:27] offset:12288
    ds_write_b128 v5, v[28:31] offset:13312
    ds_write_b128 v5, v[32:35] offset:8192
    ds_write_b128 v5, v[36:39] offset:9216
    ds_write_b128 v5, v[16:19] offset:4096
    ds_write_b128 v5, v[20:23] offset:5120
    v_pk_mul_f32 v[16:17], v[40:41], 1.0 op_sel_hi:[1,0]
    v_pk_mul_f32 v[18:19], v[42:43], 1.0 op_sel_hi:[1,0]
    v_pk_mul_f32 v[20:21], v[44:45], 1.0 op_sel_hi:[1,0]
    v_pk_mul_f32 v[22:23], v[46:47], 1.0 op_sel_hi:[1,0]
p5_redj:
    s_waitcnt lgkmcnt(0)
    s_barrier
    ds_read_b128 v[48:51], v8 offset:0
    ds_read_b128 v[52:55], v8 offset:1024
    ds_read_b128 v[56:59], v8 offset:2048
    ds_read_b128 v[60:63], v8 offset:3072
    ds_read_b128 v[64:67], v8 offset:4096
    ds_read_b128 v[68:71], v8 offset:5120
    v_pk_add_f32 v[16:17], v[16:17], v[80:81]
    v_pk_add_f32 v[18:19], v[18:19], v[82:83]
    v_pk_add_f32 v[20:21], v[20:21], v[84:85]
    v_pk_add_f32 v[22:23], v[22:23], v[86:87]
    s_waitcnt lgkmcnt(4)
    v_pk_add_f32 v[16:17], v[16:17], v[48:49]
    v_pk_add_f32 v[18:19], v[18:19], v[50:51]
    v_pk_add_f32 v[20:21], v[20:21], v[52:53]
    v_pk_add_f32 v[22:23], v[22:23], v[54:55]
    s_waitcnt lgkmcnt(2)
    v_pk_add_f32 v[16:17], v[16:17], v[56:57]
    v_pk_add_f32 v[18:19], v[18:19], v[58:59]
    v_pk_add_f32 v[20:21], v[20:21], v[60:61]
    v_pk_add_f32 v[22:23], v[22:23], v[62:63]
    s_waitcnt lgkmcnt(0)
    v_pk_add_f32 v[16:17], v[16:17], v[64:65]
    v_pk_add_f32 v[18:19], v[18:19], v[66:67]
    v_pk_add_f32 v[20:21], v[20:21], v[68:69]
    v_pk_add_f32 v[22:23], v[22:23], v[70:71]
    v_cvt_pk_bf16_f32 v12, v16, v17
    v_cvt_pk_bf16_f32 v13, v18, v19
    v_cvt_pk_bf16_f32 v14, v20, v21
    v_cvt_pk_bf16_f32 v15, v22, v23
    s_nop 0
    v_permlane32_swap_b32 v12, v14
    v_permlane32_swap_b32 v13, v15
    buffer_store_dwordx4 v[12:15], v4, s[12:15], s69 offen
all_done:
exit_now:
    s_endpgm
attn_slow:
    s_mov_b32 s35, 9
    s_mov_b32 exec_lo, 0
    v_mov_b32 v10, 0
    s_mov_b32 exec_lo, -1
    v_mov_b32 v60, 0xff800000
    s_mov_b32 s64, 0
attn_slow1:
    buffer_load_dwordx4 v[12:15], v1, s[8:11], s64 offen sc1
    buffer_load_dwordx4 v[16:19], v1, s[8:11], s64 offen offset:1024 sc1
    s_waitcnt vmcnt(0)
    v_mfma_f32_32x32x16_bf16 v[44:59], v[12:15], v[4:7], 0
    v_mfma_f32_32x32x16_bf16 v[44:59], v[16:19], v[8:11], v[44:59]
    s_nop 11
    v_max3_f32 v60, v60, v44, v45
    v_max3_f32 v60, v60, v46, v47
    v_max3_f32 v60, v60, v48, v49
    v_max3_f32 v60, v60, v50, v51
    v_max3_f32 v60, v60, v52, v53
    v_max3_f32 v60, v60, v54, v55
    v_max3_f32 v60, v60, v56, v57
    v_max3_f32 v60, v60, v58, v59
    s_add_u32 s64, s64, 2048
    s_cmp_lt_u32 s64, 0x20000
    s_cbranch_scc1 attn_slow1
    v_mov_b32 v61, v60
    s_nop 1
    v_permlane32_swap_b32 v61, v60
    v_max_f32 v60, v60, v61
    v_mov_b32 v84, 0
    v_mov_b32 v85, 0
    v_mov_b32 v86, 0
    v_mov_b32 v87, 0
    v_mov_b32 v88, 0
    v_mov_b32 v89, 0
    v_mov_b32 v90, 0
    v_mov_b32 v91, 0
    v_mov_b32 v92, 0
    v_mov_b32 v93, 0
    v_mov_b32 v94, 0
    v_mov_b32 v95, 0
    v_mov_b32 v96, 0
    v_mov_b32 v97, 0
    v_mov_b32 v98, 0
    v_mov_b32 v99, 0
    s_mov_b32 s64, 0
attn_slow2:
    buffer_load_dwordx4 v[12:15], v1, s[8:11], s64 offen sc1
    buffer_load_dwordx4 v[16:19], v1, s[8:11], s64 offen offset:1024 sc1
    buffer_load_dwordx4 v[28:31], v1, s[12:15], s64 offen sc1
    buffer_load_dwordx4 v[32:35], v1, s[12:15], s64 offen offset:1024 sc1
    s_waitcnt vmcnt(0)
    v_mfma_f32_32x32x16_bf16 v[44:59], v[12:15], v[4:7], 0
    v_mfma_f32_32x32x16_bf16 v[44:59], v[16:19], v[8:11], v[44:59]
    s_nop 11
    v_sub_f32 v44, v44, v60
    v_sub_f32 v45, v45, v60
    v_sub_f32 v46, v46, v60
    v_sub_f32 v47, v47, v60
    v_sub_f32 v48, v48, v60
    v_sub_f32 v49, v49, v60
    v_sub_f32 v50, v50, v60
    v_sub_f32 v51, v51, v60
    v_sub_f32 v52, v52, v60
    v_sub_f32 v53, v53, v60
    v_sub_f32 v54, v54, v60
    v_sub_f32 v55, v55, v60
    v_sub_f32 v56, v56, v60
    v_sub_f32 v57, v57, v60
    v_sub_f32 v58, v58, v60
    v_sub_f32 v59, v59, v60
    v_exp_f32 v44, v44
    v_exp_f32 v45, v45
    v_exp_f32 v46, v46
    v_exp_f32 v47, v47
    v_exp_f32 v48, v48
    v_exp_f32 v49, v49
    v_exp_f32 v50, v50
    v_exp_f32 v51, v51
    v_exp_f32 v52, v52
    v_exp_f32 v53, v53
    v_exp_f32 v54, v54
    v_exp_f32 v55, v55
    v_exp_f32 v56, v56
    v_exp_f32 v57, v57
    v_exp_f32 v58, v58
    v_exp_f32 v59, v59
    v_cvt_pk_bf16_f32 v76, v44, v45
    v_cvt_pk_bf16_f32 v77, v46, v47
    v_cvt_pk_bf16_f32 v78, v48, v49
    v_cvt_pk_bf16_f32 v79, v50, v51
    v_cvt_pk_bf16_f32 v80, v52, v53
    v_cvt_pk_bf16_f32 v81, v54, v55
    v_cvt_pk_bf16_f32 v82, v56, v57
    v_cvt_pk_bf16_f32 v83, v58, v59
    v_mfma_f32_32x32x16_bf16 v[84:99], v[28:31], v[76:79], v[84:99]
    s_nop 0
    v_mfma_f32_32x32x16_bf16 v[84:99], v[32:35], v[80:83], v[84:99]
    s_add_u32 s64, s64, 2048
    s_cmp_lt_u32 s64, 0x20000
    s_cbranch_scc1 attn_slow2
    s_nop 15
    v_mov_b32 v60, v96
    s_cmp_eq_u32 s34, 1
    s_cbranch_scc1 attn_norm1
    s_branch attn_norm0
code_end:
.section .rodata,"a"
.p2align 6
.amdhsa_kernel sequential_preLN__mha_block__glu_gated_swiglu__prompt_kernel
  .amdhsa_next_free_vgpr 166
  .amdhsa_next_free_sgpr 90
  .amdhsa_accum_offset 168
  .amdhsa_group_segment_fixed_size 0
  .amdhsa_kernarg_size 80
  .amdhsa_user_sgpr_count 2
  .amdhsa_user_sgpr_kernarg_segment_ptr 1
  .amdhsa_system_sgpr_workgroup_id_x 1
  .amdhsa_float_denorm_mode_32 3
.end_amdhsa_kernel
```
